```python
import torch

def _softmax(x, axis=-1):
    return torch.softmax(x, dim=axis)
def _gelu(x):
    return torch.nn.functional.gelu(x, approximate="tanh")
def _silu(x):
    return torch.nn.functional.silu(x)
def _sigmoid(x):
    return torch.sigmoid(x)
def _layernorm(x, axis=-1, eps=1e-5):
    m = x.mean(dim=axis, keepdim=True)
    v = x.var(dim=axis, keepdim=True, unbiased=False)
    return (x - m) / torch.sqrt(v + eps)
def _scatter_add(tgt, idx, src, axis=0):
    return tgt.clone().index_add_(axis, idx, src)
def _segment_sum(src, seg, n):
    out = torch.zeros((n,) + src.shape[1:], dtype=src.dtype)
    return out.index_add_(0, seg, src)
def _pad(x, pw):
    flat = tuple(v for pair in reversed(pw) for v in pair)
    return torch.nn.functional.pad(x, flat)

kernel_name = 'parallel_sum__ssm_conv_h3__glu_gated_reglu__prompt'

def setup_inputs():

    _w = (lambda a: (lambda t: t.to(torch.bfloat16) if t.is_floating_point() else t)(torch.as_tensor(a)))
    def _A_setup():
        B, S, D = 1, 2048, 512
        ks = 4
        return {
            "q": _w((lambda *s: torch.randn(*s, dtype=torch.bfloat16) * 0.05)(B, S, D)),
            "k": _w((lambda *s: torch.randn(*s, dtype=torch.bfloat16) * 0.2)(B, S, D)),
            "v": _w((lambda *s: torch.randn(*s, dtype=torch.bfloat16) * 0.2)(B, S, D)),
            "shift_k": _w((lambda *s: torch.randn(*s, dtype=torch.bfloat16) * 0.2)(D, ks) * 0.5),
            "ssm_k": _w((lambda *s: torch.randn(*s, dtype=torch.bfloat16) * 0.4)(D, S) * (1.0 / S ** 0.5)),
            "ssm_D": _w((lambda *s: torch.randn(*s, dtype=torch.bfloat16) * 0.2)(D)),
        }
    _A_in = _A_setup()

    def _B_setup():
        B, S, D, F = 1, 2048, 512, 1792
        return {
            "x": _w((lambda *s: torch.randn(*s, dtype=torch.bfloat16) * 0.05)(B, S, D)),
            "W_gate": _w((lambda *s: torch.randn(*s, dtype=torch.bfloat16) * 0.2)(D, F) * (2.0 / D) ** 0.5),
            "W_up": _w((lambda *s: torch.randn(*s, dtype=torch.bfloat16) * 0.2)(D, F) * (2.0 / D) ** 0.5),
            "W_down": _w((lambda *s: torch.randn(*s, dtype=torch.bfloat16) * 0.2)(F, D) * (1.0 / F) ** 0.5),
        }
    _B_in = _B_setup()

    return {
        "A_q": _A_in["q"],
        "A_k": _A_in["k"],
        "A_v": _A_in["v"],
        "A_shift_k": _A_in["shift_k"],
        "A_ssm_k": _A_in["ssm_k"],
        "A_ssm_D": _A_in["ssm_D"],
        "B_x": _B_in["x"],
        "B_W_gate": _B_in["W_gate"],
        "B_W_up": _B_in["W_up"],
        "B_W_down": _B_in["W_down"],
    }

def reference(A_q, A_k, A_v, A_shift_k, A_ssm_k, A_ssm_D, B_x, B_W_gate, B_W_up, B_W_down):
    def _A_ref(q, k, v, shift_k, ssm_k, ssm_D):
        B, S, D = q.shape
        ks = shift_k.shape[-1]
        k_pad = _pad(k, ((0, 0), (ks - 1, 0), (0, 0)))
        k_shift = torch.zeros_like(k)
        for t in range(ks):
            k_shift = k_shift + k_pad[:, t:t + S, :] * shift_k[:, ks - 1 - t][None, None, :]
        kv = k_shift * v
        L = 2 * S
        kv_pad = _pad(kv, ((0, 0), (0, S), (0, 0)))
        kf_pad = _pad(ssm_k, ((0, 0), (0, S)))
        kv_f = (lambda x, axes=(-2,-1): torch.fft.rfft2(x.float(), dim=axes))(kv_pad[:, None, :, :], axes=(1, 2))
        kf_f = (lambda x, axes=(-2,-1): torch.fft.rfft2(x.float(), dim=axes))(kf_pad[:, None, :], axes=(1, 2))
        kf_f = (lambda x, *d: x.permute(*d))(kf_f, 1, 2, 0)
        y_f = kv_f * kf_f[None, :, :, :]
        y = (lambda x, s, axes=(-2,-1): torch.fft.irfft2(x, s=s, dim=axes).to(torch.bfloat16))(y_f, (1, L), axes=(1, 2))[:, 0, :S, :]
        y = y + kv * ssm_D[None, None, :]
        return q * y

    def _B_ref(x, W_gate, W_up, W_down):
        gate = torch.einsum("bsd,df->bsf", x, W_gate)
        up = torch.einsum("bsd,df->bsf", x, W_up)
        gate = gate * (lambda x, dt: x.to(dt))(gate > 0, gate.dtype)
        h = gate * up
        return torch.einsum("bsf,fd->bsd", h, W_down)

    x = A_q
    xn = _layernorm(x, axis=-1)
    return x + _A_ref(xn, A_k, A_v, A_shift_k, A_ssm_k, A_ssm_D) + _B_ref(xn, B_W_gate, B_W_up, B_W_down)
```

```asm
; @launch grid=(256,1,1) block=(256,1,1) lds=163840
.amdgcn_target "amdgcn-amd-amdhsa--gfx950"
.text
.globl parallel_sum__ssm_conv_h3__glu_gated_reglu__prompt_kernel
.p2align 8
.type parallel_sum__ssm_conv_h3__glu_gated_reglu__prompt_kernel,@function
parallel_sum__ssm_conv_h3__glu_gated_reglu__prompt_kernel:
    s_load_dwordx16 s[76:91], s[0:1], 0
    s_load_dwordx8 s[92:99], s[0:1], 64
    s_load_dwordx2 s[100:101], s[0:1], 96
    s_cmp_ge_u32 s2, 256
    s_cbranch_scc1 L_end
    s_getpc_b64 s[64:65]
L_pc:
    s_mov_b32 s66, L_end-L_pc
    s_mov_b32 s67, 0x20000
    s_lshr_b32 s45, s2, 3
    v_lshlrev_b32 v5, 4, v0
    s_lshl_b32 s50, s45, 12
    buffer_load_dwordx4 a[0:3], v5, s[64:67], s50 offen
    v_lshrrev_b32 v5, 6, v0
    v_and_b32 v1, 63, v0
    v_readfirstlane_b32 s3, v5
    s_and_b32 s44, s2, 7
    s_and_b32 s47, s2, 1
    s_mul_i32 s47, s47, 7
    s_lshr_b32 s62, s2, 5
    s_add_u32 s47, s47, s62
    s_lshl_b32 s55, s3, 13
    s_cmp_ge_u32 s45, 28
    s_cbranch_scc1 L_aux
    s_and_b32 s50, s3, 1
    s_mul_i32 s50, s50, 114688
    s_lshl_b32 s51, s47, 8
    s_add_u32 s50, s50, s51
    s_lshr_b32 s52, s3, 1
    s_lshl_b32 s52, s52, 2
    v_lshrrev_b32 v5, 4, v1
    v_or_b32 v6, s52, v5
    v_lshlrev_b32 v6, 1, v6
    v_xor_b32 v6, v6, v1
    v_and_b32 v6, 15, v6
    v_mul_u32_u24 v5, 3584, v5
    v_add_u32 v5, s50, v5
    v_lshl_add_u32 v20, v6, 4, v5
    v_add_u32 v21, 13312, v20
    v_add_u32 v22, 26624, v20
    v_add_u32 v23, 39936, v20
    s_lshl_b32 s63, s44, 1
    s_and_b32 s63, s63, 4
    s_mov_b32 s14, 1835008
    s_mov_b32 s15, 0x20000
    s_cmp_ge_u32 s3, 2
    s_waitcnt lgkmcnt(0)
    s_cselect_b32 s12, s92, s90
    s_cselect_b32 s13, s93, s91
    s_add_u32 s57, s63, 0
    s_and_b32 s57, s57, 7
    s_mul_i32 s58, s57, 229376
    s_lshl_b32 s57, s57, 7
    s_add_u32 m0, s55, 0
    s_nop 0
    buffer_load_dwordx4 v20, s[12:15], s58 offen offset:0 lds
    buffer_load_dwordx4 v21, s[12:15], s58 offen offset:1024 lds
    buffer_load_dwordx4 v22, s[12:15], s58 offen offset:2048 lds
    buffer_load_dwordx4 v23, s[12:15], s58 offen offset:3072 lds
    s_add_u32 m0, s55, 4096
    s_add_u32 s58, s58, 57344
    buffer_load_dwordx4 v20, s[12:15], s58 offen offset:0 lds
    buffer_load_dwordx4 v21, s[12:15], s58 offen offset:1024 lds
    buffer_load_dwordx4 v22, s[12:15], s58 offen offset:2048 lds
    buffer_load_dwordx4 v23, s[12:15], s58 offen offset:3072 lds
    s_lshr_b32 s46, s44, 1
    s_lshl_b32 s46, s46, 2
    s_and_b32 s50, s45, 3
    s_add_u32 s46, s46, s50
    s_lshl_b32 s54, s3, 12
    s_and_b32 s51, s44, 1
    s_xor_b32 s51, s51, 1
    s_lshl_b32 s51, s51, 1
    s_xor_b32 s51, s51, s3
    s_lshl_b32 s50, s46, 17
    s_lshl_b32 s51, s51, 15
    s_add_u32 s50, s50, s51
    v_lshrrev_b32 v5, 3, v1
    v_lshlrev_b32 v5, 10, v5
    v_add_u32 v5, s50, v5
    v_lshrrev_b32 v6, 4, v1
    v_xor_b32 v6, v6, v1
    v_and_b32 v6, 7, v6
    v_xor_b32 v7, 4, v6
    v_lshl_add_u32 v16, v6, 4, v5
    v_lshl_add_u32 v17, v7, 4, v5
    v_add_u32 v17, 7168, v17
    v_lshl_add_u32 v18, v6, 4, v5
    v_add_u32 v18, 14336, v18
    v_lshl_add_u32 v19, v7, 4, v5
    v_add_u32 v19, 21504, v19
    s_mov_b32 s8, s76
    s_mov_b32 s9, s77
    s_mov_b32 s10, 2097152
    s_mov_b32 s11, 0x20000
    s_add_u32 m0, s54, 32768
    s_nop 0
    buffer_load_dwordx4 v16, s[8:11], s57 offen offset:0 lds
    buffer_load_dwordx4 v17, s[8:11], s57 offen offset:1024 lds
    buffer_load_dwordx4 v18, s[8:11], s57 offen offset:2048 lds
    buffer_load_dwordx4 v19, s[8:11], s57 offen offset:3072 lds
    v_lshlrev_b32 v4, 4, v1
    s_mov_b32 s49, 0xffff0000
    s_lshl_b32 s61, s44, 5
    s_add_u32 s61, s61, s45
    s_lshl_b32 s56, s3, 11
    s_mov_b32 s72, s62
    s_sub_u32 s53, s72, s63
    s_and_b32 s53, s53, 7
    s_lshr_b32 s0, s3, 1
    s_and_b32 s50, s62, 1
    s_xor_b32 s0, s0, s50
    s_cmp_eq_u32 s62, 7
    s_cselect_b32 s1, 0, s62
    s_load_dword s48, s[100:101], 0
    s_lshl_b32 s50, s61, 2
    s_load_dword s60, s[86:87], s50
    s_mov_b32 s24, s78
    s_mov_b32 s25, s79
    s_mov_b32 s26, 2097152
    s_mov_b32 s27, 0x20000
    s_mov_b32 s28, s80
    s_mov_b32 s29, s81
    s_mov_b32 s30, 2097152
    s_mov_b32 s31, 0x20000
    s_mov_b32 s40, s82
    s_mov_b32 s41, s83
    s_mov_b32 s42, 4096
    s_mov_b32 s43, 0x20000
    s_mov_b32 s16, s94
    s_mov_b32 s17, s95
    s_mov_b32 s18, 1835008
    s_mov_b32 s19, 0x20000
    s_mov_b32 s20, s100
    s_mov_b32 s21, s101
    s_mov_b32 s22, 33554432
    s_mov_b32 s23, 0x20000
    s_mov_b32 s32, s84
    s_mov_b32 s33, s85
    s_mov_b32 s34, 2097152
    s_mov_b32 s35, 0x20000
    s_mov_b32 s36, s96
    s_mov_b32 s37, s97
    s_mov_b32 s38, 2097152
    s_mov_b32 s39, 0x20000
    v_lshrrev_b32 v2, 5, v1
    v_lshlrev_b32 v2, 30, v2
    v_lshl_add_u32 v2, v1, 2, v2
    v_and_b32 v5, 31, v1
    v_lshrrev_b32 v6, 1, v5
    v_and_b32 v6, 7, v6
    v_lshrrev_b32 v7, 5, v1
    v_xor_b32 v6, v6, v7
    v_lshlrev_b32 v5, 7, v5
    v_xor_b32 v7, 0, v6
    v_lshl_add_u32 v24, v7, 4, v5
    v_add_u32 v28, 147456, v24
    v_xor_b32 v7, 2, v6
    v_lshl_add_u32 v25, v7, 4, v5
    v_add_u32 v29, 147456, v25
    v_xor_b32 v7, 4, v6
    v_lshl_add_u32 v26, v7, 4, v5
    v_add_u32 v30, 147456, v26
    v_xor_b32 v7, 6, v6
    v_lshl_add_u32 v27, v7, 4, v5
    v_add_u32 v31, 147456, v27
    v_bfe_u32 v5, v1, 4, 1
    v_bfe_u32 v6, v1, 2, 2
    v_lshl_add_u32 v7, v5, 2, v6
    s_lshl_b32 s50, s3, 1
    v_xor_b32 v7, s50, v7
    v_lshlrev_b32 v5, 14, v5
    v_lshl_add_u32 v5, v6, 8, v5
    v_lshrrev_b32 v8, 5, v1
    v_lshl_add_u32 v5, v8, 11, v5
    v_and_b32 v8, 3, v1
    v_lshl_add_u32 v5, v8, 3, v5
    v_lshl_add_u32 v32, v7, 5, v5
    v_xor_b32 v7, 1, v7
    v_lshl_add_u32 v33, v7, 5, v5
    v_add_u32 v34, 65536, v32
    v_add_u32 v35, 65536, v33
    s_lshl_b32 s50, s45, 16
    s_lshl_b32 s51, s44, 7
    s_add_u32 s50, s50, s51
    v_and_b32 v8, 31, v1
    v_lshlrev_b32 v7, 2, v8
    v_lshrrev_b32 v15, 5, v1
    v_lshl_add_u32 v15, v15, 10, v7
    s_sub_u32 s51, s50, 4096
    v_add_u32 v7, s51, v7
    s_add_u32 s51, s56, 97792
    v_add_u32 v15, s51, v15
    s_lshl_b32 s51, s3, 14
    s_add_u32 s50, s50, s51
    v_lshrrev_b32 v6, 3, v1
    v_lshlrev_b32 v6, 10, v6
    v_add_u32 v6, s50, v6
    v_lshlrev_b32 v8, 4, v8
    v_and_b32 v9, 7, v1
    v_lshl_add_u32 v6, v9, 4, v6
    s_cmp_eq_u32 s3, 0
    s_cselect_b32 s66, 0, -1
    s_lshl_b32 s65, s44, 9
    s_lshl_b32 s51, s0, 12
    s_add_u32 s50, s51, 8192
    s_and_b32 s51, s3, 1
    s_lshl_b32 s51, s51, 2
    v_bfe_u32 v111, v1, 1, 3
    v_xor_b32 v111, s51, v111
    v_lshlrev_b32 v111, 4, v111
    v_and_b32 v110, 31, v1
    v_lshl_add_u32 v111, v110, 7, v111
    v_lshrrev_b32 v110, 5, v1
    v_lshl_add_u32 v111, v110, 3, v111
    v_add_u32 v111, s50, v111
    s_lshl_b32 s70, s3, 1
    s_sub_u32 s70, 7, s70
    v_lshrrev_b32 v90, 5, v1
    v_sub_u32 v52, s70, v90
    v_and_b32 v93, 7, v1
    v_xor_b32 v52, v52, v93
    v_lshlrev_b32 v54, 4, v93
    v_and_b32 v93, 31, v1
    v_lshl_add_u32 v53, v93, 3, v52
    v_lshlrev_b32 v52, 4, v52
    v_lshl_add_u32 v52, v93, 8, v52
    v_add_u32 v52, 98304, v52
    v_lshlrev_b32 v53, 2, v53
    v_add_u32 v53, 106496, v53
    v_lshrrev_b32 v91, 3, v0
    v_lshl_add_u32 v54, v91, 8, v54
    v_add_u32 v54, 98304, v54
    v_xor_b32 v55, v91, v0
    v_and_b32 v55, 7, v55
    v_lshlrev_b32 v55, 4, v55
    v_mul_u32_u24 v91, 12288, v91
    v_add_u32 v55, v55, v91
    v_lshlrev_b32 v56, 2, v0
    v_add_u32 v56, 106496, v56
    s_mul_i32 s64, s44, 393216
    s_mul_i32 s71, s45, 384
    s_sub_u32 s64, s64, s71
    s_add_u32 s64, s64, 1060480
    s_and_b32 s70, s44, 1
    s_mul_i32 s70, s70, 917504
    s_lshl_b32 s71, s3, 15
    s_add_u32 s70, s70, s71
    s_lshl_b32 s71, s72, 7
    s_add_u32 s70, s70, s71
    v_lshrrev_b32 v90, 3, v1
    v_lshlrev_b32 v90, 10, v90
    v_add_u32 v90, s70, v90
    v_bfe_u32 v91, v1, 4, 1
    v_lshlrev_b32 v91, 2, v91
    v_xor_b32 v91, v91, v1
    v_and_b32 v91, 7, v91
    v_lshl_add_u32 v36, v91, 4, v90
    v_add_u32 v37, 7168, v36
    v_lshrrev_b32 v90, 5, v1
    v_lshlrev_b32 v90, 9, v90
    v_bfe_u32 v91, v1, 2, 2
    v_lshl_add_u32 v90, v91, 7, v90
    v_bfe_u32 v91, v1, 4, 1
    v_lshl_add_u32 v90, v91, 5, v90
    v_and_b32 v91, 3, v1
    v_lshl_add_u32 v40, v91, 3, v90
    v_add_u32 v90, s56, v40
    s_and_b32 s70, s3, 1
    v_bfe_u32 v91, v1, 3, 1
    v_xor_b32 v91, s70, v91
    v_lshl_add_u32 v46, v91, 6, v90
    v_xor_b32 v47, 64, v46
    v_add_u32 v38, 98304, v46
    v_add_u32 v39, 98304, v47
    s_lshr_b32 s70, s3, 1
    s_mul_i32 s68, s70, 16656
    s_add_u32 s68, s68, 116608
    s_and_b32 s69, s3, 1
    s_mul_i32 s70, s70, 9152
    s_lshl_b32 s71, s69, 8
    s_add_u32 s70, s70, s71
    s_add_u32 s70, s70, 98752
    s_add_u32 s71, s71, s68
    v_and_b32 v9, 1, v1
    v_mul_u32_u24 v9, 4576, v9
    v_bfe_u32 v10, v1, 1, 3
    v_lshlrev_b32 v10, 6, v10
    v_sub_u32 v9, v9, v10
    v_lshrrev_b32 v11, 4, v1
    v_lshl_add_u32 v9, v11, 4, v9
    v_add_u32 v41, s70, v9
    v_and_b32 v9, 15, v1
    v_add_u32 v9, 1, v9
    v_lshrrev_b32 v10, 2, v9
    v_add_u32 v10, v10, v11
    v_and_b32 v9, 3, v9
    v_min_u32 v14, 1, v9
    v_add_u32 v10, v10, v14
    v_mul_u32_u24 v9, 4160, v9
    v_lshl_add_u32 v9, v10, 4, v9
    v_add_u32 v42, s71, v9
    v_bfe_u32 v9, v1, 4, 1
    v_lshl_add_u32 v9, s69, 1, v9
    v_and_b32 v10, 15, v1
    v_add_u32 v11, v9, v10
    v_mul_u32_u24 v14, 4160, v9
    v_min_u32 v9, 1, v9
    v_cmp_gt_u32 vcc, 16, v11
    v_lshl_add_u32 v14, v9, 4, v14
    v_subrev_u32 v11, 16, v11
    v_lshlrev_b32 v11, 2, v11
    v_mov_b32 v9, 0x40000000
    v_cndmask_b32 v11, v11, v9, vcc
    v_lshl_add_u32 v14, v10, 2, v14
    v_add_u32 v14, s68, v14
    v_and_b32 v12, 31, v1
    v_lshlrev_b32 v13, 4, v12
    v_lshlrev_b32 v12, 3, v12
    v_and_b32 v91, 15, v1
    v_lshlrev_b32 v90, 10, v91
    v_lshrrev_b32 v91, 5, v1
    v_lshl_add_u32 v90, v91, 4, v90
    v_bfe_u32 v91, v1, 4, 1
    v_lshl_add_u32 v90, v91, 5, v90
    v_accvgpr_write_b32 a192, v90
    v_lshrrev_b32 v91, 3, v0
    v_and_b32 v92, 7, v0
    v_mul_u32_u24 v90, 12288, v91
    v_lshl_add_u32 v90, v92, 4, v90
    v_accvgpr_write_b32 a193, v90
    v_and_b32 v90, 1, v91
    v_lshlrev_b32 v90, 2, v90
    v_xor_b32 v90, v90, v92
    v_lshlrev_b32 v90, 4, v90
    v_lshl_add_u32 v90, v91, 8, v90
    v_add_u32 v90, 98304, v90
    v_accvgpr_write_b32 a194, v90
    v_bfe_u32 v90, v1, 3, 1
    v_xor_b32 v90, s0, v90
    v_lshl_add_u32 v90, v90, 6, v40
    s_and_b32 s70, s3, 1
    s_lshl_b32 s70, s70, 12
    s_add_u32 s70, s70, 98304
    v_add_u32 v90, s70, v90
    v_accvgpr_write_b32 a195, v90
    v_lshrrev_b32 v90, 4, v1
    v_lshlrev_b32 v90, 8, v90
    v_and_b32 v91, 15, v1
    v_lshl_add_u32 v90, v91, 3, v90
    s_add_u32 s70, s55, 65536
    v_add_u32 v90, s70, v90
    v_accvgpr_write_b32 a196, v90
    v_sub_u32 v91, 255, v0
    v_lshlrev_b32 v90, 5, v91
    v_add_u32 v90, 65536, v90
    v_accvgpr_write_b32 a197, v90
    v_lshrrev_b32 v90, 3, v91
    v_lshlrev_b32 v90, 8, v90
    v_lshl_add_u32 v90, v91, 4, v90
    v_accvgpr_write_b32 a198, v90
    v_min_u32 v90, 6, v1
    v_lshlrev_b32 v90, 9, v90
    v_accvgpr_write_b32 a199, v90
    s_xor_b32 s70, s3, 1
    s_mul_i32 s70, s70, 12288
    s_add_u32 s70, s70, 114688
    v_add_u32 v90, s70, v4
    v_accvgpr_write_b32 a200, v90
    s_xor_b32 s70, s3, 2
    s_mul_i32 s70, s70, 12288
    s_add_u32 s70, s70, 118784
    v_add_u32 v90, s70, v4
    v_accvgpr_write_b32 a201, v90
    s_xor_b32 s70, s3, 3
    s_mul_i32 s70, s70, 12288
    s_add_u32 s70, s70, 122880
    v_add_u32 v90, s70, v4
    v_accvgpr_write_b32 a202, v90
    s_mul_i32 s70, s3, 12288
    s_add_u32 s70, s70, 114688
    v_add_u32 v90, s70, v4
    v_accvgpr_write_b32 a203, v90
    s_add_u32 s70, s1, 1
    s_sub_u32 s71, s70, 7
    s_cselect_b32 s70, s70, s71
    s_lshl_b32 s70, s70, 13
    v_add_u32 v90, s70, v4
    v_accvgpr_write_b32 a204, v90
    s_add_u32 s70, s1, 2
    s_sub_u32 s71, s70, 7
    s_cselect_b32 s70, s70, s71
    s_lshl_b32 s70, s70, 13
    v_add_u32 v90, s70, v4
    v_accvgpr_write_b32 a205, v90
    s_add_u32 s70, s1, 3
    s_sub_u32 s71, s70, 7
    s_cselect_b32 s70, s70, s71
    s_lshl_b32 s70, s70, 13
    v_add_u32 v90, s70, v4
    v_accvgpr_write_b32 a206, v90
    s_add_u32 s70, s1, 4
    s_sub_u32 s71, s70, 7
    s_cselect_b32 s70, s70, s71
    s_lshl_b32 s70, s70, 13
    v_add_u32 v90, s70, v4
    v_accvgpr_write_b32 a207, v90
    s_add_u32 s70, s1, 5
    s_sub_u32 s71, s70, 7
    s_cselect_b32 s70, s70, s71
    s_lshl_b32 s70, s70, 13
    v_add_u32 v90, s70, v4
    v_accvgpr_write_b32 a208, v90
    s_add_u32 s70, s1, 6
    s_sub_u32 s71, s70, 7
    s_cselect_b32 s70, s70, s71
    s_lshl_b32 s70, s70, 13
    v_add_u32 v90, s70, v4
    v_accvgpr_write_b32 a209, v90
    s_add_u32 s57, s63, 1
    s_and_b32 s57, s57, 7
    s_mul_i32 s58, s57, 229376
    s_lshl_b32 s57, s57, 7
    s_add_u32 m0, s55, 65536
    s_nop 0
    buffer_load_dwordx4 v20, s[12:15], s58 offen offset:0 lds
    buffer_load_dwordx4 v21, s[12:15], s58 offen offset:1024 lds
    buffer_load_dwordx4 v22, s[12:15], s58 offen offset:2048 lds
    buffer_load_dwordx4 v23, s[12:15], s58 offen offset:3072 lds
    s_add_u32 m0, s55, 69632
    s_add_u32 s58, s58, 57344
    buffer_load_dwordx4 v20, s[12:15], s58 offen offset:0 lds
    buffer_load_dwordx4 v21, s[12:15], s58 offen offset:1024 lds
    buffer_load_dwordx4 v22, s[12:15], s58 offen offset:2048 lds
    buffer_load_dwordx4 v23, s[12:15], s58 offen offset:3072 lds
    s_add_u32 s50, s45, s44
    s_and_b32 s73, s50, 1
    s_waitcnt lgkmcnt(0)
    s_add_u32 s48, s48, 2654435769
    v_mov_b32 v3, s48
    s_waitcnt vmcnt(8)
    s_barrier
    ds_read_b64_tr_b16 v[112:113], v32 offset:0
    ds_read_b64_tr_b16 v[114:115], v32 offset:1024
    ds_read_b128 a[224:227], v24 offset:32768
    ds_read_b128 a[228:231], v24 offset:36864
    ds_read_b128 a[232:235], v24 offset:40960
    ds_read_b128 a[236:239], v24 offset:45056
    ds_read_b64_tr_b16 v[116:117], v33 offset:0
    ds_read_b64_tr_b16 v[118:119], v33 offset:1024
    s_waitcnt lgkmcnt(5)
    v_mfma_f32_32x32x16_bf16 v[128:143], v[112:115], a[224:227], 0
    ds_read_b64_tr_b16 v[120:121], v32 offset:4096
    s_add_u32 m0, s54, 49152
    s_nop 0
    buffer_load_dwordx4 v16, s[8:11], s57 offen offset:0 lds
    s_waitcnt lgkmcnt(5)
    v_mfma_f32_32x32x16_bf16 v[144:159], v[112:115], a[228:231], 0
    ds_read_b64_tr_b16 v[122:123], v32 offset:5120
    s_lshl_b32 s70, s3, 3
    s_and_b32 s70, s70, 16
    s_lshr_b32 s70, s60, s70
    s_and_b32 s70, s70, 0xffff
    s_waitcnt lgkmcnt(5)
    v_mfma_f32_32x32x16_bf16 v[160:175], v[112:115], a[232:235], 0
    ds_read_b128 a[240:243], v25 offset:32768
    s_bitcmp1_b32 s3, 0
    s_cselect_b32 s70, 0, s70
    v_and_b32 v9, 15, v1
    v_lshrrev_b32 v10, 4, v1
    s_waitcnt lgkmcnt(5)
    v_mfma_f32_32x32x16_bf16 v[176:191], v[112:115], a[236:239], 0
    ds_read_b128 a[244:247], v25 offset:36864
    v_lshl_add_u32 v9, v10, 2, v9
    v_mov_b32 v90, s70
    v_cmp_eq_u32 vcc, 15, v9
    s_nop 1
    s_waitcnt lgkmcnt(4)
    v_mfma_f32_32x32x16_bf16 v[192:207], v[116:119], a[224:227], 0
    ds_read_b128 a[248:251], v25 offset:40960
    v_cndmask_b32 v10, 0, v90, vcc
    v_accvgpr_write_b32 a108, v10
    v_cmp_eq_u32 vcc, 14, v9
    s_nop 1
    s_cmp_lg_u32 s53, 0
    s_cbranch_scc1 L_xc_1
    ds_read_b64 a[216:217], v111 offset:32768
    v_xor_b32 v110, 16, v111
    ds_read_b64 a[218:219], v110 offset:32768
    v_xor_b32 v110, 32, v111
    ds_read_b64 a[220:221], v110 offset:32768
    v_xor_b32 v110, 48, v111
    ds_read_b64 a[222:223], v110 offset:32768
L_xc_1:
    v_mfma_f32_32x32x16_bf16 v[208:223], v[116:119], a[228:231], 0
    ds_read_b128 a[252:255], v25 offset:45056
    v_cndmask_b32 v10, 0, v90, vcc
    v_accvgpr_write_b32 a109, v10
    v_cmp_eq_u32 vcc, 13, v9
    s_nop 1
    v_mfma_f32_32x32x16_bf16 v[224:239], v[116:119], a[232:235], 0
    ds_read_b64_tr_b16 v[124:125], v33 offset:4096
    v_cndmask_b32 v10, 0, v90, vcc
    v_accvgpr_write_b32 a110, v10
    v_cmp_eq_u32 vcc, 12, v9
    s_nop 1
    v_mfma_f32_32x32x16_bf16 v[240:255], v[116:119], a[236:239], 0
    ds_read_b64_tr_b16 v[126:127], v33 offset:5120
    v_cndmask_b32 v10, 0, v90, vcc
    v_accvgpr_write_b32 a111, v10
    s_waitcnt lgkmcnt(5)
    v_mfma_f32_32x32x16_bf16 v[128:143], v[120:123], a[240:243], v[128:143]
    ds_read_b64_tr_b16 v[112:113], v32 offset:8192
    buffer_load_dwordx4 v17, s[8:11], s57 offen offset:1024 lds
    s_waitcnt lgkmcnt(5)
    v_mfma_f32_32x32x16_bf16 v[144:159], v[120:123], a[244:247], v[144:159]
    ds_read_b64_tr_b16 v[114:115], v32 offset:9216
    buffer_load_dwordx4 v18, s[8:11], s57 offen offset:2048 lds
    s_waitcnt lgkmcnt(5)
    v_mfma_f32_32x32x16_bf16 v[160:175], v[120:123], a[248:251], v[160:175]
    ds_read_b128 a[224:227], v26 offset:32768
    buffer_load_dwordx4 v19, s[8:11], s57 offen offset:3072 lds
    s_waitcnt lgkmcnt(5)
    v_mfma_f32_32x32x16_bf16 v[176:191], v[120:123], a[252:255], v[176:191]
    ds_read_b128 a[228:231], v26 offset:36864
    s_cmp_lg_u32 s73, 0
    s_cbranch_scc1 L_cb_2
    s_cmp_lg_u32 s3, 0
    s_cbranch_scc1 L_halo_3
    s_mov_b32 exec_hi, 0
    buffer_load_dword v60, v7, s[24:27], 0 offen offset:0
    buffer_load_dword v61, v7, s[24:27], 0 offen offset:1024
    buffer_load_dword v62, v7, s[24:27], 0 offen offset:2048
    buffer_load_dword v63, v7, s[24:27], 0 offen offset:3072
    buffer_load_dword v72, v7, s[28:31], 0 offen offset:3072
    s_mov_b32 exec_hi, -1
L_halo_3:
    s_movk_i32 s50, 7168
    s_add_u32 m0, s56, 98304
    s_nop 0
    buffer_load_dwordx4 v6, s[24:27], 0 offen nt lds
    buffer_load_dwordx4 v6, s[24:27], s50 offen offset:1024 nt lds
    s_add_u32 m0, s56, 106496
    s_nop 0
    buffer_load_dwordx4 v6, s[28:31], 0 offen nt lds
    buffer_load_dwordx4 v6, s[28:31], s50 offen offset:1024 nt lds
    buffer_load_dwordx4 v[82:85], v8, s[40:43], s65 offen
L_cb_2:
    s_waitcnt lgkmcnt(4)
    v_mfma_f32_32x32x16_bf16 v[192:207], v[124:127], a[240:243], v[192:207]
    ds_read_b128 a[232:235], v26 offset:40960
    s_add_u32 s57, s63, 2
    s_and_b32 s57, s57, 7
    s_mul_i32 s58, s57, 229376
    s_lshl_b32 s57, s57, 7
    s_add_u32 m0, s55, 114688
    s_nop 0
    buffer_load_dwordx4 v20, s[12:15], s58 offen offset:0 lds
    v_mfma_f32_32x32x16_bf16 v[208:223], v[124:127], a[244:247], v[208:223]
    ds_read_b128 a[236:239], v26 offset:45056
    v_mfma_f32_32x32x16_bf16 v[224:239], v[124:127], a[248:251], v[224:239]
    ds_read_b64_tr_b16 v[116:117], v33 offset:8192
    buffer_load_dwordx4 v21, s[12:15], s58 offen offset:1024 lds
    v_mfma_f32_32x32x16_bf16 v[240:255], v[124:127], a[252:255], v[240:255]
    ds_read_b64_tr_b16 v[118:119], v33 offset:9216
    s_waitcnt lgkmcnt(5)
    v_mfma_f32_32x32x16_bf16 v[128:143], v[112:115], a[224:227], v[128:143]
    ds_read_b64_tr_b16 v[120:121], v32 offset:12288
    ds_read_b64_tr_b16 v[122:123], v32 offset:13312
    buffer_load_dwordx4 v22, s[12:15], s58 offen offset:2048 lds
    s_waitcnt lgkmcnt(6)
    v_mfma_f32_32x32x16_bf16 v[144:159], v[112:115], a[228:231], v[144:159]
    ds_read_b128 a[240:243], v27 offset:32768
    ds_read_b128 a[244:247], v27 offset:36864
    s_waitcnt lgkmcnt(7)
    v_mfma_f32_32x32x16_bf16 v[160:175], v[112:115], a[232:235], v[160:175]
    ds_read_b128 a[248:251], v27 offset:40960
    ds_read_b128 a[252:255], v27 offset:45056
    buffer_load_dwordx4 v23, s[12:15], s58 offen offset:3072 lds
    s_waitcnt lgkmcnt(8)
    v_mfma_f32_32x32x16_bf16 v[176:191], v[112:115], a[236:239], v[176:191]
    ds_read_b64_tr_b16 v[124:125], v33 offset:12288
    ds_read_b64_tr_b16 v[126:127], v33 offset:13312
    s_waitcnt lgkmcnt(8)
    v_mfma_f32_32x32x16_bf16 v[192:207], v[116:119], a[224:227], v[192:207]
    s_add_u32 m0, s55, 118784
    s_add_u32 s58, s58, 57344
    buffer_load_dwordx4 v20, s[12:15], s58 offen offset:0 lds
    v_mfma_f32_32x32x16_bf16 v[208:223], v[116:119], a[228:231], v[208:223]
    v_mfma_f32_32x32x16_bf16 v[224:239], v[116:119], a[232:235], v[224:239]
    buffer_load_dwordx4 v21, s[12:15], s58 offen offset:1024 lds
    v_mfma_f32_32x32x16_bf16 v[240:255], v[116:119], a[236:239], v[240:255]
    buffer_load_dwordx4 v22, s[12:15], s58 offen offset:2048 lds
    s_cmp_lg_u32 s73, 0
    s_cbranch_scc1 L_cwn_5
    s_waitcnt vmcnt(12)
    s_branch L_cw_4
L_cwn_5:
    s_waitcnt vmcnt(7)
L_cw_4:
    s_waitcnt lgkmcnt(0)
    s_barrier
    v_mfma_f32_32x32x16_bf16 v[128:143], v[120:123], a[240:243], v[128:143]
    ds_read_b64_tr_b16 v[112:113], v34 offset:0
    v_mfma_f32_32x32x16_bf16 v[144:159], v[120:123], a[244:247], v[144:159]
    ds_read_b64_tr_b16 v[114:115], v34 offset:1024
    buffer_load_dwordx4 v23, s[12:15], s58 offen offset:3072 lds
    v_mfma_f32_32x32x16_bf16 v[160:175], v[120:123], a[248:251], v[160:175]
    ds_read_b128 a[224:227], v24 offset:49152
    v_mfma_f32_32x32x16_bf16 v[176:191], v[120:123], a[252:255], v[176:191]
    ds_read_b128 a[228:231], v24 offset:53248
    s_add_u32 m0, s54, 147456
    s_nop 0
    buffer_load_dwordx4 v16, s[8:11], s57 offen offset:0 lds
    v_mfma_f32_32x32x16_bf16 v[192:207], v[124:127], a[240:243], v[192:207]
    ds_read_b128 a[232:235], v24 offset:57344
    v_mfma_f32_32x32x16_bf16 v[208:223], v[124:127], a[244:247], v[208:223]
    ds_read_b128 a[236:239], v24 offset:61440
    buffer_load_dwordx4 v17, s[8:11], s57 offen offset:1024 lds
    v_mfma_f32_32x32x16_bf16 v[224:239], v[124:127], a[248:251], v[224:239]
    ds_read_b64_tr_b16 v[116:117], v35 offset:0
    v_mfma_f32_32x32x16_bf16 v[240:255], v[124:127], a[252:255], v[240:255]
    ds_read_b64_tr_b16 v[118:119], v35 offset:1024
    buffer_load_dwordx4 v18, s[8:11], s57 offen offset:2048 lds
    s_waitcnt lgkmcnt(5)
    v_mfma_f32_32x32x16_bf16 v[128:143], v[112:115], a[224:227], v[128:143]
    ds_read_b64_tr_b16 v[120:121], v34 offset:4096
    buffer_load_dwordx4 v19, s[8:11], s57 offen offset:3072 lds
    s_waitcnt lgkmcnt(5)
    v_mfma_f32_32x32x16_bf16 v[144:159], v[112:115], a[228:231], v[144:159]
    ds_read_b64_tr_b16 v[122:123], v34 offset:5120
    s_waitcnt lgkmcnt(5)
    v_mfma_f32_32x32x16_bf16 v[160:175], v[112:115], a[232:235], v[160:175]
    ds_read_b128 a[240:243], v25 offset:49152
    s_cmp_lg_u32 s73, 1
    s_cbranch_scc1 L_cb_6
    s_cmp_lg_u32 s3, 0
    s_cbranch_scc1 L_halo_7
    s_mov_b32 exec_hi, 0
    buffer_load_dword v60, v7, s[24:27], 0 offen offset:0
    buffer_load_dword v61, v7, s[24:27], 0 offen offset:1024
    buffer_load_dword v62, v7, s[24:27], 0 offen offset:2048
    buffer_load_dword v63, v7, s[24:27], 0 offen offset:3072
    buffer_load_dword v72, v7, s[28:31], 0 offen offset:3072
    s_mov_b32 exec_hi, -1
L_halo_7:
    s_movk_i32 s50, 7168
    s_add_u32 m0, s56, 98304
    s_nop 0
    buffer_load_dwordx4 v6, s[24:27], 0 offen nt lds
    buffer_load_dwordx4 v6, s[24:27], s50 offen offset:1024 nt lds
    s_add_u32 m0, s56, 106496
    s_nop 0
    buffer_load_dwordx4 v6, s[28:31], 0 offen nt lds
    buffer_load_dwordx4 v6, s[28:31], s50 offen offset:1024 nt lds
    buffer_load_dwordx4 v[82:85], v8, s[40:43], s65 offen
L_cb_6:
    s_waitcnt lgkmcnt(5)
    v_mfma_f32_32x32x16_bf16 v[176:191], v[112:115], a[236:239], v[176:191]
    ds_read_b128 a[244:247], v25 offset:53248
    s_add_u32 s57, s63, 3
    s_and_b32 s57, s57, 7
    s_mul_i32 s58, s57, 229376
    s_lshl_b32 s57, s57, 7
    s_add_u32 m0, s55, 0
    s_nop 0
    buffer_load_dwordx4 v20, s[12:15], s58 offen offset:0 lds
    s_waitcnt lgkmcnt(4)
    v_mfma_f32_32x32x16_bf16 v[192:207], v[116:119], a[224:227], v[192:207]
    ds_read_b128 a[248:251], v25 offset:57344
    buffer_load_dwordx4 v21, s[12:15], s58 offen offset:1024 lds
    s_and_b32 s70, s44, 1
    s_cmp_lg_u32 s53, 1
    s_cbranch_scc1 L_xc_8
    ds_read_b64 a[216:217], v111 offset:49152
    v_xor_b32 v110, 16, v111
    ds_read_b64 a[218:219], v110 offset:49152
    v_xor_b32 v110, 32, v111
    ds_read_b64 a[220:221], v110 offset:49152
    v_xor_b32 v110, 48, v111
    ds_read_b64 a[222:223], v110 offset:49152
L_xc_8:
    v_mfma_f32_32x32x16_bf16 v[208:223], v[116:119], a[228:231], v[208:223]
    ds_read_b128 a[252:255], v25 offset:61440
    buffer_load_dwordx4 v22, s[12:15], s58 offen offset:2048 lds
    s_lshl_b32 s41, s46, 1
    v_mfma_f32_32x32x16_bf16 v[224:239], v[116:119], a[232:235], v[224:239]
    ds_read_b64_tr_b16 v[124:125], v35 offset:4096
    buffer_load_dwordx4 v23, s[12:15], s58 offen offset:3072 lds
    s_add_u32 s41, s41, s70
    v_mfma_f32_32x32x16_bf16 v[240:255], v[116:119], a[236:239], v[240:255]
    ds_read_b64_tr_b16 v[126:127], v35 offset:5120
    s_add_u32 m0, s55, 4096
    s_add_u32 s58, s58, 57344
    buffer_load_dwordx4 v20, s[12:15], s58 offen offset:0 lds
    s_waitcnt lgkmcnt(5)
    v_mfma_f32_32x32x16_bf16 v[128:143], v[120:123], a[240:243], v[128:143]
    ds_read_b64_tr_b16 v[112:113], v34 offset:8192
    buffer_load_dwordx4 v21, s[12:15], s58 offen offset:1024 lds
    s_lshl_b32 s31, s41, 1
    s_waitcnt lgkmcnt(5)
    v_mfma_f32_32x32x16_bf16 v[144:159], v[120:123], a[244:247], v[144:159]
    ds_read_b64_tr_b16 v[114:115], v34 offset:9216
    buffer_load_dwordx4 v22, s[12:15], s58 offen offset:2048 lds
    s_mul_i32 s25, s31, 114688
    s_waitcnt lgkmcnt(5)
    v_mfma_f32_32x32x16_bf16 v[160:175], v[120:123], a[248:251], v[160:175]
    ds_read_b128 a[224:227], v26 offset:49152
    buffer_load_dwordx4 v23, s[12:15], s58 offen offset:3072 lds
    s_xor_b32 s24, s31, 2
    s_waitcnt lgkmcnt(5)
    v_mfma_f32_32x32x16_bf16 v[176:191], v[120:123], a[252:255], v[176:191]
    ds_read_b128 a[228:231], v26 offset:53248
    s_add_u32 m0, s54, 32768
    s_nop 0
    buffer_load_dwordx4 v16, s[8:11], s57 offen offset:0 lds
    s_waitcnt lgkmcnt(4)
    v_mfma_f32_32x32x16_bf16 v[192:207], v[124:127], a[240:243], v[192:207]
    ds_read_b128 a[232:235], v26 offset:57344
    buffer_load_dwordx4 v17, s[8:11], s57 offen offset:1024 lds
    s_mul_i32 s24, s24, 114688
    v_mfma_f32_32x32x16_bf16 v[208:223], v[124:127], a[244:247], v[208:223]
    ds_read_b128 a[236:239], v26 offset:61440
    buffer_load_dwordx4 v18, s[8:11], s57 offen offset:2048 lds
    s_lshl_b32 s71, s47, 13
    v_mfma_f32_32x32x16_bf16 v[224:239], v[124:127], a[248:251], v[224:239]
    ds_read_b64_tr_b16 v[116:117], v35 offset:8192
    buffer_load_dwordx4 v19, s[8:11], s57 offen offset:3072 lds
    s_add_u32 s71, s71, s56
    v_mfma_f32_32x32x16_bf16 v[240:255], v[124:127], a[252:255], v[240:255]
    ds_read_b64_tr_b16 v[118:119], v35 offset:9216
    s_add_u32 s71, s71, 11534336
    s_add_u32 s24, s24, s71
    s_add_u32 s25, s25, s71
    s_lshl_b32 s27, s41, 12
    s_waitcnt lgkmcnt(5)
    v_mfma_f32_32x32x16_bf16 v[128:143], v[112:115], a[224:227], v[128:143]
    ds_read_b64_tr_b16 v[120:121], v34 offset:12288
    ds_read_b64_tr_b16 v[122:123], v34 offset:13312
    s_add_u32 s27, s27, 524288
    s_lshl_b32 s71, s62, 9
    s_add_u32 s26, s27, s71
    s_waitcnt lgkmcnt(6)
    v_mfma_f32_32x32x16_bf16 v[144:159], v[112:115], a[228:231], v[144:159]
    ds_read_b128 a[240:243], v27 offset:49152
    ds_read_b128 a[244:247], v27 offset:53248
    s_lshl_b32 s71, s3, 7
    s_add_u32 s26, s26, s71
    s_add_u32 s27, s27, s71
    s_waitcnt lgkmcnt(7)
    v_mfma_f32_32x32x16_bf16 v[160:175], v[112:115], a[232:235], v[160:175]
    ds_read_b128 a[248:251], v27 offset:57344
    ds_read_b128 a[252:255], v27 offset:61440
    s_add_u32 s31, s31, s0
    s_lshl_b32 s43, s31, 15
    s_lshl_b32 s71, s72, 7
    s_waitcnt lgkmcnt(8)
    v_mfma_f32_32x32x16_bf16 v[176:191], v[112:115], a[236:239], v[176:191]
    ds_read_b64_tr_b16 v[124:125], v35 offset:12288
    ds_read_b64_tr_b16 v[126:127], v35 offset:13312
    s_add_u32 s43, s43, s71
    s_and_b32 s71, s3, 1
    s_lshl_b32 s71, s71, 6
    s_waitcnt lgkmcnt(8)
    v_mfma_f32_32x32x16_bf16 v[192:207], v[116:119], a[224:227], v[192:207]
    s_add_u32 s43, s43, s71
    s_mul_i32 s70, s70, 57344
    s_add_u32 s70, s70, s56
    s_add_u32 s70, s70, 11534336
    s_xor_b32 s28, s31, 3
    v_mfma_f32_32x32x16_bf16 v[208:223], v[116:119], a[228:231], v[208:223]
    s_xor_b32 s29, s31, 2
    s_xor_b32 s30, s31, 1
    s_mul_i32 s28, s28, 114688
    s_add_u32 s28, s28, s70
    s_mul_i32 s29, s29, 114688
    v_mfma_f32_32x32x16_bf16 v[224:239], v[116:119], a[232:235], v[224:239]
    s_add_u32 s29, s29, s70
    s_mul_i32 s30, s30, 114688
    s_add_u32 s30, s30, s70
    s_mul_i32 s31, s31, 114688
    s_add_u32 s31, s31, s70
    v_mfma_f32_32x32x16_bf16 v[240:255], v[116:119], a[236:239], v[240:255]
    s_mul_i32 s41, s41, 384
    s_mul_i32 s71, s72, 393216
    s_add_u32 s41, s41, s71
    s_add_u32 s41, s41, 4194304
    s_mul_i32 s40, s61, 12288
    s_cmp_lg_u32 s73, 0
    s_cbranch_scc1 L_cwn_10
    s_waitcnt vmcnt(24)
    s_branch L_cw_9
L_cwn_10:
    s_waitcnt vmcnt(12)
L_cw_9:
    s_waitcnt vmcnt(12) lgkmcnt(0)
    s_barrier
    v_mfma_f32_32x32x16_bf16 v[128:143], v[120:123], a[240:243], v[128:143]
    ds_read_b64_tr_b16 v[112:113], v34 offset:49152
    s_add_u32 s57, s63, 4
    s_and_b32 s57, s57, 7
    s_mul_i32 s58, s57, 229376
    s_lshl_b32 s57, s57, 7
    s_add_u32 m0, s55, 65536
    s_nop 0
    buffer_load_dwordx4 v20, s[12:15], s58 offen offset:0 lds
    v_mfma_f32_32x32x16_bf16 v[144:159], v[120:123], a[244:247], v[144:159]
    ds_read_b64_tr_b16 v[114:115], v34 offset:50176
    buffer_load_dwordx4 v21, s[12:15], s58 offen offset:1024 lds
    s_mov_b32 exec_lo, s66
    ds_read2_b32 v[60:61], v15 offset0:0 offset1:32
    ds_read2_b32 v[62:63], v15 offset0:64 offset1:96
    ds_read_b32 v72, v15 offset:8576
    s_mov_b32 exec_lo, -1
    v_mfma_f32_32x32x16_bf16 v[160:175], v[120:123], a[248:251], v[160:175]
    ds_read_b128 a[224:227], v28 offset:0
    v_add_u32 v9, 512, v15
    ds_read2_b32 v[64:65], v9 offset0:0 offset1:32
    ds_read2_b32 v[66:67], v9 offset0:64 offset1:96
    ds_read2_b32 v[68:69], v9 offset0:128 offset1:160
    v_mfma_f32_32x32x16_bf16 v[176:191], v[120:123], a[252:255], v[176:191]
    ds_read_b128 a[228:231], v28 offset:4096
    buffer_load_dwordx4 v22, s[12:15], s58 offen offset:2048 lds
    ds_read2_b32 v[70:71], v9 offset0:192 offset1:224
    v_mfma_f32_32x32x16_bf16 v[192:207], v[124:127], a[240:243], v[192:207]
    ds_read_b128 a[232:235], v28 offset:8192
    ds_read_b32 v73, v9 offset:8192
    ds_read_b32 v80, v9 offset:9088
    v_add_u32 v9, 8192, v9
    ds_read2_b32 v[74:75], v9 offset0:32 offset1:64
    v_mfma_f32_32x32x16_bf16 v[208:223], v[124:127], a[244:247], v[208:223]
    ds_read_b128 a[236:239], v28 offset:12288
    buffer_load_dwordx4 v23, s[12:15], s58 offen offset:3072 lds
    ds_read2_b32 v[76:77], v9 offset0:96 offset1:128
    v_mfma_f32_32x32x16_bf16 v[224:239], v[124:127], a[248:251], v[224:239]
    ds_read_b64_tr_b16 v[116:117], v35 offset:49152
    ds_read2_b32 v[78:79], v9 offset0:160 offset1:192
    s_add_u32 s40, s40, 4194304
    s_lshl_b32 s42, s2, 14
    s_add_u32 s42, s42, s54
    v_mfma_f32_32x32x16_bf16 v[240:255], v[124:127], a[252:255], v[240:255]
    ds_read_b64_tr_b16 v[118:119], v35 offset:50176
    s_add_u32 m0, s55, 69632
    s_add_u32 s58, s58, 57344
    buffer_load_dwordx4 v20, s[12:15], s58 offen offset:0 lds
    s_waitcnt lgkmcnt(14)
    v_mfma_f32_32x32x16_bf16 v[128:143], v[112:115], a[224:227], v[128:143]
    ds_read_b64_tr_b16 v[120:121], v34 offset:53248
    s_add_u32 s42, s42, 7340032
    v_accvgpr_read_b32 v5, a199
    s_waitcnt lgkmcnt(11)
    v_mfma_f32_32x32x16_bf16 v[144:159], v[112:115], a[228:231], v[144:159]
    ds_read_b64_tr_b16 v[122:123], v34 offset:54272
    buffer_load_dwordx4 v21, s[12:15], s58 offen offset:1024 lds
    s_waitcnt lgkmcnt(10)
    v_mfma_f32_32x32x16_bf16 v[160:175], v[112:115], a[232:235], v[160:175]
    ds_read_b128 a[240:243], v29 offset:0
    s_waitcnt lgkmcnt(4)
    v_lshlrev_b32 v86, 16, v82
    v_lshlrev_b32 v87, 16, v84
    v_and_b32 v88, s49, v82
    v_mfma_f32_32x32x16_bf16 v[176:191], v[112:115], a[236:239], v[176:191]
    ds_read_b128 a[244:247], v29 offset:4096
    buffer_load_dwordx4 v22, s[12:15], s58 offen offset:2048 lds
    v_and_b32 v89, s49, v84
    s_waitcnt lgkmcnt(4)
    v_mfma_f32_32x32x16_bf16 v[192:207], v[116:119], a[224:227], v[192:207]
    ds_read_b128 a[248:251], v29 offset:8192
    v_lshlrev_b32 v90, 16, v83
    v_lshlrev_b32 v91, 16, v85
    v_and_b32 v92, s49, v83
    v_and_b32 v93, s49, v85
    s_cmp_lg_u32 s53, 2
    s_cbranch_scc1 L_xc_11
    v_add_u32 v43, 147456, v111
    ds_read_b64 a[216:217], v43 offset:0
    v_xor_b32 v110, 16, v43
    ds_read_b64 a[218:219], v110 offset:0
    v_xor_b32 v110, 32, v43
    ds_read_b64 a[220:221], v110 offset:0
    v_xor_b32 v110, 48, v43
    ds_read_b64 a[222:223], v110 offset:0
L_xc_11:
    v_mfma_f32_32x32x16_bf16 v[208:223], v[116:119], a[228:231], v[208:223]
    ds_read_b128 a[252:255], v29 offset:12288
    buffer_load_dwordx4 v23, s[12:15], s58 offen offset:3072 lds
    v_lshlrev_b32 v94, 16, v60
    v_mfma_f32_32x32x16_bf16 v[224:239], v[116:119], a[232:235], v[224:239]
    ds_read_b64_tr_b16 v[124:125], v35 offset:53248
    v_and_b32 v95, s49, v60
    v_lshlrev_b32 v96, 16, v61
    v_and_b32 v97, s49, v61
    v_lshlrev_b32 v98, 16, v62
    v_mfma_f32_32x32x16_bf16 v[240:255], v[116:119], a[236:239], v[240:255]
    ds_read_b64_tr_b16 v[126:127], v35 offset:54272
    s_add_u32 m0, s54, 49152
    s_nop 0
    buffer_load_dwordx4 v16, s[8:11], s57 offen offset:0 lds
    s_waitcnt lgkmcnt(5)
    v_mfma_f32_32x32x16_bf16 v[128:143], v[120:123], a[240:243], v[128:143]
    ds_read_b64_tr_b16 v[112:113], v34 offset:57344
    buffer_load_dwordx4 v17, s[8:11], s57 offen offset:1024 lds
    v_and_b32 v99, s49, v62
    s_waitcnt lgkmcnt(5)
    v_mfma_f32_32x32x16_bf16 v[144:159], v[120:123], a[244:247], v[144:159]
    ds_read_b64_tr_b16 v[114:115], v34 offset:58368
    v_lshlrev_b32 v100, 16, v63
    v_and_b32 v101, s49, v63
    v_mul_f32 v84, v100, v86
    v_mul_f32 v85, v101, v87
    s_waitcnt lgkmcnt(5)
    v_mfma_f32_32x32x16_bf16 v[160:175], v[120:123], a[248:251], v[160:175]
    ds_read_b128 a[224:227], v30 offset:0
    buffer_load_dwordx4 v18, s[8:11], s57 offen offset:2048 lds
    v_fmac_f32 v84, v98, v88
    s_waitcnt lgkmcnt(5)
    v_mfma_f32_32x32x16_bf16 v[176:191], v[120:123], a[252:255], v[176:191]
    ds_read_b128 a[228:231], v30 offset:4096
    v_fmac_f32 v85, v99, v89
    v_fmac_f32 v84, v96, v90
    v_fmac_f32 v85, v97, v91
    v_fmac_f32 v84, v94, v92
    s_waitcnt lgkmcnt(4)
    v_mfma_f32_32x32x16_bf16 v[192:207], v[124:127], a[240:243], v[192:207]
    ds_read_b128 a[232:235], v30 offset:8192
    buffer_load_dwordx4 v19, s[8:11], s57 offen offset:3072 lds
    v_fmac_f32 v85, v95, v93
    v_mfma_f32_32x32x16_bf16 v[208:223], v[124:127], a[244:247], v[208:223]
    ds_read_b128 a[236:239], v30 offset:12288
    v_lshlrev_b32 v9, 16, v72
    v_and_b32 v10, s49, v72
    v_mul_f32 v84, v84, v9
    v_mul_f32 v85, v85, v10
    v_mfma_f32_32x32x16_bf16 v[224:239], v[124:127], a[248:251], v[224:239]
    ds_read_b64_tr_b16 v[116:117], v35 offset:57344
    v_cvt_pk_bf16_f32 v81, v84, v85
    v_lshlrev_b32 v94, 16, v64
    v_and_b32 v95, s49, v64
    v_mul_f32 v82, v94, v86
    v_mfma_f32_32x32x16_bf16 v[240:255], v[124:127], a[252:255], v[240:255]
    ds_read_b64_tr_b16 v[118:119], v35 offset:58368
    v_mul_f32 v83, v95, v87
    v_fmac_f32 v82, v100, v88
    v_fmac_f32 v83, v101, v89
    v_fmac_f32 v82, v98, v90
    s_waitcnt lgkmcnt(5)
    v_mfma_f32_32x32x16_bf16 v[128:143], v[112:115], a[224:227], v[128:143]
    ds_read_b64_tr_b16 v[120:121], v34 offset:61440
    ds_read_b64_tr_b16 v[122:123], v34 offset:62464
    v_fmac_f32 v83, v99, v91
    v_fmac_f32 v82, v96, v92
    v_fmac_f32 v83, v97, v93
    s_waitcnt lgkmcnt(6)
    v_mfma_f32_32x32x16_bf16 v[144:159], v[112:115], a[228:231], v[144:159]
    ds_read_b128 a[240:243], v31 offset:0
    ds_read_b128 a[244:247], v31 offset:4096
    v_lshlrev_b32 v9, 16, v73
    v_and_b32 v10, s49, v73
    v_mul_f32 v82, v82, v9
    s_waitcnt lgkmcnt(7)
    v_mfma_f32_32x32x16_bf16 v[160:175], v[112:115], a[232:235], v[160:175]
    ds_read_b128 a[248:251], v31 offset:8192
    ds_read_b128 a[252:255], v31 offset:12288
    v_mul_f32 v83, v83, v10
    v_lshlrev_b32 v96, 16, v65
    v_and_b32 v97, s49, v65
    s_waitcnt lgkmcnt(8)
    v_mfma_f32_32x32x16_bf16 v[176:191], v[112:115], a[236:239], v[176:191]
    ds_read_b64_tr_b16 v[124:125], v35 offset:61440
    ds_read_b64_tr_b16 v[126:127], v35 offset:62464
    v_mul_f32 v84, v96, v86
    v_mul_f32 v85, v97, v87
    v_fmac_f32 v84, v94, v88
    s_waitcnt lgkmcnt(8)
    v_mfma_f32_32x32x16_bf16 v[192:207], v[116:119], a[224:227], v[192:207]
    v_fmac_f32 v85, v95, v89
    v_fmac_f32 v84, v100, v90
    v_fmac_f32 v85, v101, v91
    v_fmac_f32 v84, v98, v92
    v_fmac_f32 v85, v99, v93
    v_mfma_f32_32x32x16_bf16 v[208:223], v[116:119], a[228:231], v[208:223]
    v_lshlrev_b32 v9, 16, v74
    v_and_b32 v10, s49, v74
    v_mul_f32 v84, v84, v9
    v_mul_f32 v85, v85, v10
    v_cvt_pk_bf16_f32 v105, v84, v82
    v_mfma_f32_32x32x16_bf16 v[224:239], v[116:119], a[232:235], v[224:239]
    v_cvt_pk_bf16_f32 v109, v85, v83
    v_lshlrev_b32 v98, 16, v66
    v_and_b32 v99, s49, v66
    v_mul_f32 v82, v98, v86
    v_mul_f32 v83, v99, v87
    v_mfma_f32_32x32x16_bf16 v[240:255], v[116:119], a[236:239], v[240:255]
    v_fmac_f32 v82, v96, v88
    v_fmac_f32 v83, v97, v89
    v_fmac_f32 v82, v94, v90
    v_fmac_f32 v83, v95, v91
    v_fmac_f32 v82, v100, v92
    s_waitcnt vmcnt(12) lgkmcnt(0)
    s_barrier
    v_mfma_f32_32x32x16_bf16 v[128:143], v[120:123], a[240:243], v[128:143]
    ds_read_b64_tr_b16 v[112:113], v32 offset:0
    s_add_u32 s57, s63, 5
    s_and_b32 s57, s57, 7
    s_mul_i32 s58, s57, 229376
    s_lshl_b32 s57, s57, 7
    s_add_u32 m0, s55, 114688
    s_nop 0
    buffer_load_dwordx4 v20, s[12:15], s58 offen offset:0 lds
    v_mfma_f32_32x32x16_bf16 v[144:159], v[120:123], a[244:247], v[144:159]
    ds_read_b64_tr_b16 v[114:115], v32 offset:1024
    buffer_load_dwordx4 v21, s[12:15], s58 offen offset:1024 lds
    v_fmac_f32 v83, v101, v93
    v_mfma_f32_32x32x16_bf16 v[160:175], v[120:123], a[248:251], v[160:175]
    ds_read_b128 a[224:227], v24 offset:32768
    v_lshlrev_b32 v9, 16, v75
    v_and_b32 v10, s49, v75
    v_mul_f32 v82, v82, v9
    v_mul_f32 v83, v83, v10
    v_mfma_f32_32x32x16_bf16 v[176:191], v[120:123], a[252:255], v[176:191]
    ds_read_b128 a[228:231], v24 offset:36864
    buffer_load_dwordx4 v22, s[12:15], s58 offen offset:2048 lds
    v_lshlrev_b32 v100, 16, v67
    v_mfma_f32_32x32x16_bf16 v[192:207], v[124:127], a[240:243], v[192:207]
    ds_read_b128 a[232:235], v24 offset:40960
    v_and_b32 v101, s49, v67
    v_mul_f32 v84, v100, v86
    v_mul_f32 v85, v101, v87
    v_fmac_f32 v84, v98, v88
    v_mfma_f32_32x32x16_bf16 v[208:223], v[124:127], a[244:247], v[208:223]
    ds_read_b128 a[236:239], v24 offset:45056
    buffer_load_dwordx4 v23, s[12:15], s58 offen offset:3072 lds
    v_fmac_f32 v85, v99, v89
    v_mfma_f32_32x32x16_bf16 v[224:239], v[124:127], a[248:251], v[224:239]
    ds_read_b64_tr_b16 v[116:117], v33 offset:0
    v_fmac_f32 v84, v96, v90
    v_fmac_f32 v85, v97, v91
    v_fmac_f32 v84, v94, v92
    v_fmac_f32 v85, v95, v93
    v_mfma_f32_32x32x16_bf16 v[240:255], v[124:127], a[252:255], v[240:255]
    ds_read_b64_tr_b16 v[118:119], v33 offset:1024
    s_add_u32 m0, s55, 118784
    s_add_u32 s58, s58, 57344
    buffer_load_dwordx4 v20, s[12:15], s58 offen offset:0 lds
    s_waitcnt lgkmcnt(5)
    v_mfma_f32_32x32x16_bf16 v[128:143], v[112:115], a[224:227], v[128:143]
    ds_read_b64_tr_b16 v[120:121], v32 offset:4096
    v_lshlrev_b32 v9, 16, v76
    v_and_b32 v10, s49, v76
    v_mul_f32 v84, v84, v9
    v_mul_f32 v85, v85, v10
    s_waitcnt lgkmcnt(5)
    v_mfma_f32_32x32x16_bf16 v[144:159], v[112:115], a[228:231], v[144:159]
    ds_read_b64_tr_b16 v[122:123], v32 offset:5120
    buffer_load_dwordx4 v21, s[12:15], s58 offen offset:1024 lds
    v_cvt_pk_bf16_f32 v104, v84, v82
    s_waitcnt lgkmcnt(5)
    v_mfma_f32_32x32x16_bf16 v[160:175], v[112:115], a[232:235], v[160:175]
    ds_read_b128 a[240:243], v25 offset:32768
    v_cvt_pk_bf16_f32 v108, v85, v83
    v_lshlrev_b32 v94, 16, v68
    v_and_b32 v95, s49, v68
    v_mul_f32 v82, v94, v86
    s_waitcnt lgkmcnt(5)
    v_mfma_f32_32x32x16_bf16 v[176:191], v[112:115], a[236:239], v[176:191]
    ds_read_b128 a[244:247], v25 offset:36864
    buffer_load_dwordx4 v22, s[12:15], s58 offen offset:2048 lds
    v_mul_f32 v83, v95, v87
    s_waitcnt lgkmcnt(4)
    v_mfma_f32_32x32x16_bf16 v[192:207], v[116:119], a[224:227], v[192:207]
    ds_read_b128 a[248:251], v25 offset:40960
    v_fmac_f32 v82, v100, v88
    v_fmac_f32 v83, v101, v89
    v_fmac_f32 v82, v98, v90
    v_fmac_f32 v83, v99, v91
    s_cmp_lg_u32 s53, 3
    s_cbranch_scc1 L_xc_12
    ds_read_b64 a[216:217], v111 offset:32768
    v_xor_b32 v110, 16, v111
    ds_read_b64 a[218:219], v110 offset:32768
    v_xor_b32 v110, 32, v111
    ds_read_b64 a[220:221], v110 offset:32768
    v_xor_b32 v110, 48, v111
    ds_read_b64 a[222:223], v110 offset:32768
L_xc_12:
    v_mfma_f32_32x32x16_bf16 v[208:223], v[116:119], a[228:231], v[208:223]
    ds_read_b128 a[252:255], v25 offset:45056
    buffer_load_dwordx4 v23, s[12:15], s58 offen offset:3072 lds
    v_fmac_f32 v82, v96, v92
    v_mfma_f32_32x32x16_bf16 v[224:239], v[116:119], a[232:235], v[224:239]
    ds_read_b64_tr_b16 v[124:125], v33 offset:4096
    v_fmac_f32 v83, v97, v93
    v_lshlrev_b32 v9, 16, v77
    v_and_b32 v10, s49, v77
    v_mul_f32 v82, v82, v9
    v_mfma_f32_32x32x16_bf16 v[240:255], v[116:119], a[236:239], v[240:255]
    ds_read_b64_tr_b16 v[126:127], v33 offset:5120
    s_add_u32 m0, s54, 147456
    s_nop 0
    buffer_load_dwordx4 v16, s[8:11], s57 offen offset:0 lds
    s_waitcnt lgkmcnt(5)
    v_mfma_f32_32x32x16_bf16 v[128:143], v[120:123], a[240:243], v[128:143]
    ds_read_b64_tr_b16 v[112:113], v32 offset:8192
    buffer_load_dwordx4 v17, s[8:11], s57 offen offset:1024 lds
    v_mul_f32 v83, v83, v10
    s_waitcnt lgkmcnt(5)
    v_mfma_f32_32x32x16_bf16 v[144:159], v[120:123], a[244:247], v[144:159]
    ds_read_b64_tr_b16 v[114:115], v32 offset:9216
    v_lshlrev_b32 v96, 16, v69
    v_and_b32 v97, s49, v69
    v_mul_f32 v84, v96, v86
    v_mul_f32 v85, v97, v87
    s_waitcnt lgkmcnt(5)
    v_mfma_f32_32x32x16_bf16 v[160:175], v[120:123], a[248:251], v[160:175]
    ds_read_b128 a[224:227], v26 offset:32768
    buffer_load_dwordx4 v18, s[8:11], s57 offen offset:2048 lds
    v_fmac_f32 v84, v94, v88
    s_waitcnt lgkmcnt(5)
    v_mfma_f32_32x32x16_bf16 v[176:191], v[120:123], a[252:255], v[176:191]
    ds_read_b128 a[228:231], v26 offset:36864
    v_fmac_f32 v85, v95, v89
    v_fmac_f32 v84, v100, v90
    v_fmac_f32 v85, v101, v91
    v_fmac_f32 v84, v98, v92
    s_waitcnt lgkmcnt(4)
    v_mfma_f32_32x32x16_bf16 v[192:207], v[124:127], a[240:243], v[192:207]
    ds_read_b128 a[232:235], v26 offset:40960
    buffer_load_dwordx4 v19, s[8:11], s57 offen offset:3072 lds
    v_fmac_f32 v85, v99, v93
    v_mfma_f32_32x32x16_bf16 v[208:223], v[124:127], a[244:247], v[208:223]
    ds_read_b128 a[236:239], v26 offset:45056
    v_lshlrev_b32 v9, 16, v78
    v_and_b32 v10, s49, v78
    v_mul_f32 v84, v84, v9
    v_mul_f32 v85, v85, v10
    v_mfma_f32_32x32x16_bf16 v[224:239], v[124:127], a[248:251], v[224:239]
    ds_read_b64_tr_b16 v[116:117], v33 offset:8192
    v_cvt_pk_bf16_f32 v103, v84, v82
    v_cvt_pk_bf16_f32 v107, v85, v83
    v_lshlrev_b32 v98, 16, v70
    v_and_b32 v99, s49, v70
    v_mfma_f32_32x32x16_bf16 v[240:255], v[124:127], a[252:255], v[240:255]
    ds_read_b64_tr_b16 v[118:119], v33 offset:9216
    v_mul_f32 v82, v98, v86
    v_mul_f32 v83, v99, v87
    v_fmac_f32 v82, v96, v88
    v_fmac_f32 v83, v97, v89
    s_waitcnt lgkmcnt(5)
    v_mfma_f32_32x32x16_bf16 v[128:143], v[112:115], a[224:227], v[128:143]
    ds_read_b64_tr_b16 v[120:121], v32 offset:12288
    ds_read_b64_tr_b16 v[122:123], v32 offset:13312
    v_fmac_f32 v82, v94, v90
    v_fmac_f32 v83, v95, v91
    v_fmac_f32 v82, v100, v92
    s_waitcnt lgkmcnt(6)
    v_mfma_f32_32x32x16_bf16 v[144:159], v[112:115], a[228:231], v[144:159]
    ds_read_b128 a[240:243], v27 offset:32768
    ds_read_b128 a[244:247], v27 offset:36864
    v_fmac_f32 v83, v101, v93
    v_lshlrev_b32 v9, 16, v79
    v_and_b32 v10, s49, v79
    s_waitcnt lgkmcnt(7)
    v_mfma_f32_32x32x16_bf16 v[160:175], v[112:115], a[232:235], v[160:175]
    ds_read_b128 a[248:251], v27 offset:40960
    ds_read_b128 a[252:255], v27 offset:45056
    v_mul_f32 v82, v82, v9
    v_mul_f32 v83, v83, v10
    v_lshlrev_b32 v100, 16, v71
    s_waitcnt lgkmcnt(8)
    v_mfma_f32_32x32x16_bf16 v[176:191], v[112:115], a[236:239], v[176:191]
    ds_read_b64_tr_b16 v[124:125], v33 offset:12288
    ds_read_b64_tr_b16 v[126:127], v33 offset:13312
    v_and_b32 v101, s49, v71
    v_mul_f32 v84, v100, v86
    v_mul_f32 v85, v101, v87
    s_waitcnt lgkmcnt(8)
    v_mfma_f32_32x32x16_bf16 v[192:207], v[116:119], a[224:227], v[192:207]
    v_fmac_f32 v84, v98, v88
    v_fmac_f32 v85, v99, v89
    v_fmac_f32 v84, v96, v90
    v_fmac_f32 v85, v97, v91
    v_fmac_f32 v84, v94, v92
    v_mfma_f32_32x32x16_bf16 v[208:223], v[116:119], a[228:231], v[208:223]
    v_fmac_f32 v85, v95, v93
    v_lshlrev_b32 v9, 16, v80
    v_and_b32 v10, s49, v80
    v_mul_f32 v84, v84, v9
    v_mul_f32 v85, v85, v10
    v_mfma_f32_32x32x16_bf16 v[224:239], v[116:119], a[232:235], v[224:239]
    v_cvt_pk_bf16_f32 v102, v84, v82
    v_cvt_pk_bf16_f32 v106, v85, v83
    v_mfma_f32_32x32x16_bf16 v[240:255], v[116:119], a[236:239], v[240:255]
    s_waitcnt vmcnt(12) lgkmcnt(0)
    s_barrier
    v_mfma_f32_32x32x16_bf16 v[128:143], v[120:123], a[240:243], v[128:143]
    ds_read_b64_tr_b16 v[112:113], v34 offset:0
    s_add_u32 s57, s63, 6
    s_and_b32 s57, s57, 7
    s_mul_i32 s58, s57, 229376
    s_lshl_b32 s57, s57, 7
    s_add_u32 m0, s55, 0
    s_nop 0
    buffer_load_dwordx4 v20, s[12:15], s58 offen offset:0 lds
    v_mfma_f32_32x32x16_bf16 v[144:159], v[120:123], a[244:247], v[144:159]
    ds_read_b64_tr_b16 v[114:115], v34 offset:1024
    buffer_load_dwordx4 v21, s[12:15], s58 offen offset:1024 lds
    ds_write_b128 v52, v[102:105]
    v_mfma_f32_32x32x16_bf16 v[160:175], v[120:123], a[248:251], v[160:175]
    ds_read_b128 a[224:227], v24 offset:49152
    ds_write_b128 v52, v[106:109] offset:128
    ds_write_b32 v53, v81
    v_mfma_f32_32x32x16_bf16 v[176:191], v[120:123], a[252:255], v[176:191]
    ds_read_b128 a[228:231], v24 offset:53248
    buffer_load_dwordx4 v22, s[12:15], s58 offen offset:2048 lds
    v_mfma_f32_32x32x16_bf16 v[192:207], v[124:127], a[240:243], v[192:207]
    ds_read_b128 a[232:235], v24 offset:57344
    v_mfma_f32_32x32x16_bf16 v[208:223], v[124:127], a[244:247], v[208:223]
    ds_read_b128 a[236:239], v24 offset:61440
    buffer_load_dwordx4 v23, s[12:15], s58 offen offset:3072 lds
    v_mfma_f32_32x32x16_bf16 v[224:239], v[124:127], a[248:251], v[224:239]
    ds_read_b64_tr_b16 v[116:117], v35 offset:0
    v_mfma_f32_32x32x16_bf16 v[240:255], v[124:127], a[252:255], v[240:255]
    ds_read_b64_tr_b16 v[118:119], v35 offset:1024
    s_add_u32 m0, s55, 4096
    s_add_u32 s58, s58, 57344
    buffer_load_dwordx4 v20, s[12:15], s58 offen offset:0 lds
    s_waitcnt lgkmcnt(7)
    v_mfma_f32_32x32x16_bf16 v[128:143], v[112:115], a[224:227], v[128:143]
    ds_read_b64_tr_b16 v[120:121], v34 offset:4096
    s_waitcnt lgkmcnt(5)
    v_mfma_f32_32x32x16_bf16 v[144:159], v[112:115], a[228:231], v[144:159]
    ds_read_b64_tr_b16 v[122:123], v34 offset:5120
    buffer_load_dwordx4 v21, s[12:15], s58 offen offset:1024 lds
    s_waitcnt lgkmcnt(5)
    v_mfma_f32_32x32x16_bf16 v[160:175], v[112:115], a[232:235], v[160:175]
    ds_read_b128 a[240:243], v25 offset:49152
    s_waitcnt lgkmcnt(5)
    v_mfma_f32_32x32x16_bf16 v[176:191], v[112:115], a[236:239], v[176:191]
    ds_read_b128 a[244:247], v25 offset:53248
    buffer_load_dwordx4 v22, s[12:15], s58 offen offset:2048 lds
    s_waitcnt lgkmcnt(4)
    v_mfma_f32_32x32x16_bf16 v[192:207], v[116:119], a[224:227], v[192:207]
    ds_read_b128 a[248:251], v25 offset:57344
    s_cmp_lg_u32 s53, 4
    s_cbranch_scc1 L_xc_13
    ds_read_b64 a[216:217], v111 offset:49152
    v_xor_b32 v110, 16, v111
    ds_read_b64 a[218:219], v110 offset:49152
    v_xor_b32 v110, 32, v111
    ds_read_b64 a[220:221], v110 offset:49152
    v_xor_b32 v110, 48, v111
    ds_read_b64 a[222:223], v110 offset:49152
L_xc_13:
    v_mfma_f32_32x32x16_bf16 v[208:223], v[116:119], a[228:231], v[208:223]
    ds_read_b128 a[252:255], v25 offset:61440
    buffer_load_dwordx4 v23, s[12:15], s58 offen offset:3072 lds
    v_mfma_f32_32x32x16_bf16 v[224:239], v[116:119], a[232:235], v[224:239]
    ds_read_b64_tr_b16 v[124:125], v35 offset:4096
    v_mfma_f32_32x32x16_bf16 v[240:255], v[116:119], a[236:239], v[240:255]
    ds_read_b64_tr_b16 v[126:127], v35 offset:5120
    s_add_u32 m0, s54, 32768
    s_nop 0
    buffer_load_dwordx4 v16, s[8:11], s57 offen offset:0 lds
    s_waitcnt lgkmcnt(5)
    v_mfma_f32_32x32x16_bf16 v[128:143], v[120:123], a[240:243], v[128:143]
    ds_read_b64_tr_b16 v[112:113], v34 offset:8192
    buffer_load_dwordx4 v17, s[8:11], s57 offen offset:1024 lds
    s_waitcnt lgkmcnt(5)
    v_mfma_f32_32x32x16_bf16 v[144:159], v[120:123], a[244:247], v[144:159]
    ds_read_b64_tr_b16 v[114:115], v34 offset:9216
    s_waitcnt lgkmcnt(5)
    v_mfma_f32_32x32x16_bf16 v[160:175], v[120:123], a[248:251], v[160:175]
    ds_read_b128 a[224:227], v26 offset:49152
    buffer_load_dwordx4 v18, s[8:11], s57 offen offset:2048 lds
    s_waitcnt lgkmcnt(5)
    v_mfma_f32_32x32x16_bf16 v[176:191], v[120:123], a[252:255], v[176:191]
    ds_read_b128 a[228:231], v26 offset:53248
    s_waitcnt lgkmcnt(4)
    v_mfma_f32_32x32x16_bf16 v[192:207], v[124:127], a[240:243], v[192:207]
    ds_read_b128 a[232:235], v26 offset:57344
    buffer_load_dwordx4 v19, s[8:11], s57 offen offset:3072 lds
    v_mfma_f32_32x32x16_bf16 v[208:223], v[124:127], a[244:247], v[208:223]
    ds_read_b128 a[236:239], v26 offset:61440
    v_mfma_f32_32x32x16_bf16 v[224:239], v[124:127], a[248:251], v[224:239]
    ds_read_b64_tr_b16 v[116:117], v35 offset:8192
    v_mfma_f32_32x32x16_bf16 v[240:255], v[124:127], a[252:255], v[240:255]
    ds_read_b64_tr_b16 v[118:119], v35 offset:9216
    s_waitcnt lgkmcnt(5)
    v_mfma_f32_32x32x16_bf16 v[128:143], v[112:115], a[224:227], v[128:143]
    ds_read_b64_tr_b16 v[120:121], v34 offset:12288
    ds_read_b64_tr_b16 v[122:123], v34 offset:13312
    s_waitcnt lgkmcnt(6)
    v_mfma_f32_32x32x16_bf16 v[144:159], v[112:115], a[228:231], v[144:159]
    ds_read_b128 a[240:243], v27 offset:49152
    ds_read_b128 a[244:247], v27 offset:53248
    s_waitcnt lgkmcnt(7)
    v_mfma_f32_32x32x16_bf16 v[160:175], v[112:115], a[232:235], v[160:175]
    ds_read_b128 a[248:251], v27 offset:57344
    ds_read_b128 a[252:255], v27 offset:61440
    s_waitcnt lgkmcnt(8)
    v_mfma_f32_32x32x16_bf16 v[176:191], v[112:115], a[236:239], v[176:191]
    ds_read_b64_tr_b16 v[124:125], v35 offset:12288
    ds_read_b64_tr_b16 v[126:127], v35 offset:13312
    s_waitcnt lgkmcnt(8)
    v_mfma_f32_32x32x16_bf16 v[192:207], v[116:119], a[224:227], v[192:207]
    v_mfma_f32_32x32x16_bf16 v[208:223], v[116:119], a[228:231], v[208:223]
    v_mfma_f32_32x32x16_bf16 v[224:239], v[116:119], a[232:235], v[224:239]
    v_mfma_f32_32x32x16_bf16 v[240:255], v[116:119], a[236:239], v[240:255]
    s_waitcnt vmcnt(12) lgkmcnt(0)
    s_barrier
    v_mfma_f32_32x32x16_bf16 v[128:143], v[120:123], a[240:243], v[128:143]
    ds_read_b64_tr_b16 v[112:113], v34 offset:49152
    s_add_u32 s57, s63, 7
    s_and_b32 s57, s57, 7
    s_mul_i32 s58, s57, 229376
    s_lshl_b32 s57, s57, 7
    s_add_u32 m0, s55, 65536
    s_nop 0
    buffer_load_dwordx4 v20, s[12:15], s58 offen offset:0 lds
    v_mfma_f32_32x32x16_bf16 v[144:159], v[120:123], a[244:247], v[144:159]
    ds_read_b64_tr_b16 v[114:115], v34 offset:50176
    buffer_load_dwordx4 v21, s[12:15], s58 offen offset:1024 lds
    ds_read_b128 v[102:105], v54
    v_mfma_f32_32x32x16_bf16 v[160:175], v[120:123], a[248:251], v[160:175]
    ds_read_b128 a[224:227], v28 offset:0
    ds_read_b128 v[106:109], v54 offset:128
    ds_read_b32 v96, v56
    v_mfma_f32_32x32x16_bf16 v[176:191], v[120:123], a[252:255], v[176:191]
    ds_read_b128 a[228:231], v28 offset:4096
    buffer_load_dwordx4 v22, s[12:15], s58 offen offset:2048 lds
    v_mfma_f32_32x32x16_bf16 v[192:207], v[124:127], a[240:243], v[192:207]
    ds_read_b128 a[232:235], v28 offset:8192
    v_mfma_f32_32x32x16_bf16 v[208:223], v[124:127], a[244:247], v[208:223]
    ds_read_b128 a[236:239], v28 offset:12288
    buffer_load_dwordx4 v23, s[12:15], s58 offen offset:3072 lds
    v_mfma_f32_32x32x16_bf16 v[224:239], v[124:127], a[248:251], v[224:239]
    ds_read_b64_tr_b16 v[116:117], v35 offset:49152
    v_mfma_f32_32x32x16_bf16 v[240:255], v[124:127], a[252:255], v[240:255]
    ds_read_b64_tr_b16 v[118:119], v35 offset:50176
    s_add_u32 m0, s55, 69632
    s_add_u32 s58, s58, 57344
    buffer_load_dwordx4 v20, s[12:15], s58 offen offset:0 lds
    s_waitcnt lgkmcnt(7)
    v_mfma_f32_32x32x16_bf16 v[128:143], v[112:115], a[224:227], v[128:143]
    ds_read_b64_tr_b16 v[120:121], v34 offset:53248
    s_waitcnt lgkmcnt(6)
    v_mov_b32 v94, v105
    v_mov_b32 v95, v109
    v_mov_b32 v97, s48
    s_waitcnt lgkmcnt(5)
    v_mfma_f32_32x32x16_bf16 v[144:159], v[112:115], a[228:231], v[144:159]
    ds_read_b64_tr_b16 v[122:123], v34 offset:54272
    buffer_load_dwordx4 v21, s[12:15], s58 offen offset:1024 lds
    v_mov_b32 v105, s48
    s_waitcnt lgkmcnt(5)
    v_mfma_f32_32x32x16_bf16 v[160:175], v[112:115], a[232:235], v[160:175]
    ds_read_b128 a[240:243], v29 offset:0
    v_mov_b32 v109, s48
    s_waitcnt lgkmcnt(5)
    v_mfma_f32_32x32x16_bf16 v[176:191], v[112:115], a[236:239], v[176:191]
    ds_read_b128 a[244:247], v29 offset:4096
    buffer_load_dwordx4 v22, s[12:15], s58 offen offset:2048 lds
    s_waitcnt lgkmcnt(4)
    v_mfma_f32_32x32x16_bf16 v[192:207], v[116:119], a[224:227], v[192:207]
    ds_read_b128 a[248:251], v29 offset:8192
    s_cmp_lg_u32 s53, 5
    s_cbranch_scc1 L_xc_14
    v_add_u32 v43, 147456, v111
    ds_read_b64 a[216:217], v43 offset:0
    v_xor_b32 v110, 16, v43
    ds_read_b64 a[218:219], v110 offset:0
    v_xor_b32 v110, 32, v43
    ds_read_b64 a[220:221], v110 offset:0
    v_xor_b32 v110, 48, v43
    ds_read_b64 a[222:223], v110 offset:0
L_xc_14:
    v_mfma_f32_32x32x16_bf16 v[208:223], v[116:119], a[228:231], v[208:223]
    ds_read_b128 a[252:255], v29 offset:12288
    buffer_load_dwordx4 v23, s[12:15], s58 offen offset:3072 lds
    v_mfma_f32_32x32x16_bf16 v[224:239], v[116:119], a[232:235], v[224:239]
    ds_read_b64_tr_b16 v[124:125], v35 offset:53248
    v_mfma_f32_32x32x16_bf16 v[240:255], v[116:119], a[236:239], v[240:255]
    ds_read_b64_tr_b16 v[126:127], v35 offset:54272
    s_add_u32 m0, s54, 49152
    s_nop 0
    buffer_load_dwordx4 v16, s[8:11], s57 offen offset:0 lds
    s_waitcnt lgkmcnt(5)
    v_mfma_f32_32x32x16_bf16 v[128:143], v[120:123], a[240:243], v[128:143]
    ds_read_b64_tr_b16 v[112:113], v34 offset:57344
    buffer_load_dwordx4 v17, s[8:11], s57 offen offset:1024 lds
    s_waitcnt lgkmcnt(5)
    v_mfma_f32_32x32x16_bf16 v[144:159], v[120:123], a[244:247], v[144:159]
    ds_read_b64_tr_b16 v[114:115], v34 offset:58368
    s_waitcnt lgkmcnt(5)
    v_mfma_f32_32x32x16_bf16 v[160:175], v[120:123], a[248:251], v[160:175]
    ds_read_b128 a[224:227], v30 offset:0
    buffer_load_dwordx4 v18, s[8:11], s57 offen offset:2048 lds
    s_waitcnt lgkmcnt(5)
    v_mfma_f32_32x32x16_bf16 v[176:191], v[120:123], a[252:255], v[176:191]
    ds_read_b128 a[228:231], v30 offset:4096
    s_waitcnt lgkmcnt(4)
    v_mfma_f32_32x32x16_bf16 v[192:207], v[124:127], a[240:243], v[192:207]
    ds_read_b128 a[232:235], v30 offset:8192
    buffer_load_dwordx4 v19, s[8:11], s57 offen offset:3072 lds
    v_mfma_f32_32x32x16_bf16 v[208:223], v[124:127], a[244:247], v[208:223]
    ds_read_b128 a[236:239], v30 offset:12288
    v_mfma_f32_32x32x16_bf16 v[224:239], v[124:127], a[248:251], v[224:239]
    ds_read_b64_tr_b16 v[116:117], v35 offset:57344
    s_lshl_b32 s50, s45, 15
    s_add_u32 s50, s50, s55
    s_and_b32 s51, s44, 1
    s_mul_i32 s51, s51, 917504
    s_add_u32 s50, s50, s51
    v_lshlrev_b32 v110, 10, v1
    s_mov_b64 exec, 0xff
    buffer_load_dword a190, v110, s[16:19], s50 offen offset:384
    s_mov_b64 exec, -1
    v_mfma_f32_32x32x16_bf16 v[240:255], v[124:127], a[252:255], v[240:255]
    ds_read_b64_tr_b16 v[118:119], v35 offset:58368
    s_lshl_b32 s66, s47, 12
    s_lshr_b32 s67, s56, 1
    s_add_u32 s66, s66, s67
    s_add_u32 s66, s66, 196608
    s_waitcnt lgkmcnt(5)
    v_mfma_f32_32x32x16_bf16 v[128:143], v[112:115], a[224:227], v[128:143]
    ds_read_b64_tr_b16 v[120:121], v34 offset:61440
    ds_read_b64_tr_b16 v[122:123], v34 offset:62464
    s_lshl_b32 s67, s46, 11
    s_and_b32 s74, s44, 1
    s_lshl_b32 s74, s74, 10
    s_waitcnt lgkmcnt(6)
    v_mfma_f32_32x32x16_bf16 v[144:159], v[112:115], a[228:231], v[144:159]
    ds_read_b128 a[240:243], v31 offset:0
    ds_read_b128 a[244:247], v31 offset:4096
    s_add_u32 s67, s67, s74
    s_lshl_b32 s65, s0, 9
    s_add_u32 s65, s65, s67
    s_waitcnt lgkmcnt(7)
    v_mfma_f32_32x32x16_bf16 v[160:175], v[112:115], a[232:235], v[160:175]
    ds_read_b128 a[248:251], v31 offset:8192
    ds_read_b128 a[252:255], v31 offset:12288
    s_add_u32 s65, s65, 65536
    s_add_u32 s67, s67, 131072
    s_xor_b32 s75, s67, 1024
    s_waitcnt lgkmcnt(8)
    v_mfma_f32_32x32x16_bf16 v[176:191], v[112:115], a[236:239], v[176:191]
    ds_read_b64_tr_b16 v[124:125], v35 offset:61440
    ds_read_b64_tr_b16 v[126:127], v35 offset:62464
    buffer_store_dwordx4 v[102:105], v55, s[20:23], s64 offen offset:0 sc1
    s_waitcnt lgkmcnt(8)
    v_mfma_f32_32x32x16_bf16 v[192:207], v[116:119], a[224:227], v[192:207]
    v_mfma_f32_32x32x16_bf16 v[208:223], v[116:119], a[228:231], v[208:223]
    buffer_store_dwordx4 v[106:109], v55, s[20:23], s64 offen offset:128 sc1
    v_mfma_f32_32x32x16_bf16 v[224:239], v[116:119], a[232:235], v[224:239]
    v_mfma_f32_32x32x16_bf16 v[240:255], v[116:119], a[236:239], v[240:255]
    buffer_store_dwordx4 v[94:97], v55, s[20:23], s64 offen offset:256 sc1
    s_nop 0
    s_mul_i32 s71, s61, 12288
    s_add_u32 s71, s71, 1048576
    s_waitcnt vmcnt(16) lgkmcnt(0)
    s_barrier
    v_mfma_f32_32x32x16_bf16 v[128:143], v[120:123], a[240:243], v[128:143]
    ds_read_b64_tr_b16 v[112:113], v32 offset:0
    s_lshr_b32 s64, s3, 1
    s_lshl_b32 s57, s61, 1
    s_add_u32 s57, s57, s64
    s_lshl_b32 s57, s57, 12
    v_mfma_f32_32x32x16_bf16 v[144:159], v[120:123], a[244:247], v[144:159]
    ds_read_b64_tr_b16 v[114:115], v32 offset:1024
    s_mov_b32 exec_hi, 0
    buffer_load_dword v11, v11, s[32:35], s57 offen
    s_mov_b32 exec_hi, -1
    s_lshl_b32 s64, s69, 3
    s_add_u32 s57, s57, s64
    v_mfma_f32_32x32x16_bf16 v[160:175], v[120:123], a[248:251], v[160:175]
    ds_read_b128 a[224:227], v24 offset:32768
    s_mul_i32 s64, s69, 8336
    s_add_u32 s64, s64, s68
    s_add_u32 m0, s64, 64
    s_nop 0
    buffer_load_dwordx4 v4, s[32:35], s57 offen offset:0 lds
    v_mfma_f32_32x32x16_bf16 v[176:191], v[120:123], a[252:255], v[176:191]
    ds_read_b128 a[228:231], v24 offset:36864
    s_mov_b32 s70, 0x07060302
    v_lshrrev_b32 v7, 3, v0
    v_mul_u32_u24 v7, 384, v7
    v_and_b32 v15, 7, v0
    v_mfma_f32_32x32x16_bf16 v[192:207], v[124:127], a[240:243], v[192:207]
    ds_read_b128 a[232:235], v24 offset:40960
    v_lshl_add_u32 v7, v15, 4, v7
    v_lshlrev_b32 v15, 4, v0
    v_add_u32 v15, 98304, v15
    v_mov_b32 v100, 0
    v_mfma_f32_32x32x16_bf16 v[208:223], v[124:127], a[244:247], v[208:223]
    ds_read_b128 a[236:239], v24 offset:45056
    v_mov_b32 v101, 0
    v_mov_b32 v102, 0
    v_mov_b32 v103, 0
    v_and_b32 v6, 31, v1
    v_mfma_f32_32x32x16_bf16 v[224:239], v[124:127], a[248:251], v[224:239]
    ds_read_b64_tr_b16 v[116:117], v33 offset:0
    buffer_load_dwordx4 v4, s[32:35], s57 offen offset:1024 lds
    v_min_u32 v6, 27, v6
    v_mfma_f32_32x32x16_bf16 v[240:255], v[124:127], a[252:255], v[240:255]
    ds_read_b64_tr_b16 v[118:119], v33 offset:1024
    v_lshlrev_b32 v6, 4, v6
    s_mul_i32 s50, s3, 4576
    s_add_u32 s50, s50, 102400
    v_add_u32 v6, s50, v6
    s_waitcnt lgkmcnt(5)
    v_mfma_f32_32x32x16_bf16 v[128:143], v[112:115], a[224:227], v[128:143]
    ds_read_b64_tr_b16 v[120:121], v32 offset:4096
    v_accvgpr_read_b32 v16, a192
    v_accvgpr_read_b32 v18, a193
    v_accvgpr_read_b32 v19, a194
    v_accvgpr_read_b32 v20, a195
    s_waitcnt lgkmcnt(5)
    v_mfma_f32_32x32x16_bf16 v[144:159], v[112:115], a[228:231], v[144:159]
    ds_read_b64_tr_b16 v[122:123], v32 offset:5120
    v_accvgpr_read_b32 v21, a196
    v_accvgpr_read_b32 v22, a197
    v_accvgpr_read_b32 v23, a198
    v_accvgpr_read_b32 v28, a204
    s_waitcnt lgkmcnt(5)
    v_mfma_f32_32x32x16_bf16 v[160:175], v[112:115], a[232:235], v[160:175]
    ds_read_b128 a[240:243], v25 offset:32768
    buffer_load_dwordx4 v4, s[32:35], s57 offen offset:2048 lds
    v_accvgpr_read_b32 v29, a205
    s_waitcnt lgkmcnt(5)
    v_mfma_f32_32x32x16_bf16 v[176:191], v[112:115], a[236:239], v[176:191]
    ds_read_b128 a[244:247], v25 offset:36864
    v_accvgpr_read_b32 v30, a206
    v_accvgpr_read_b32 v31, a207
    s_waitcnt lgkmcnt(4)
    v_mfma_f32_32x32x16_bf16 v[192:207], v[116:119], a[224:227], v[192:207]
    ds_read_b128 a[248:251], v25 offset:40960
    s_cmp_lg_u32 s53, 6
    s_cbranch_scc1 L_xc_15
    ds_read_b64 a[216:217], v111 offset:32768
    v_xor_b32 v110, 16, v111
    ds_read_b64 a[218:219], v110 offset:32768
    v_xor_b32 v110, 32, v111
    ds_read_b64 a[220:221], v110 offset:32768
    v_xor_b32 v110, 48, v111
    ds_read_b64 a[222:223], v110 offset:32768
L_xc_15:
    v_mfma_f32_32x32x16_bf16 v[208:223], v[116:119], a[228:231], v[208:223]
    ds_read_b128 a[252:255], v25 offset:45056
    v_mfma_f32_32x32x16_bf16 v[224:239], v[116:119], a[232:235], v[224:239]
    ds_read_b64_tr_b16 v[124:125], v33 offset:4096
    buffer_load_dwordx4 v4, s[32:35], s57 offen offset:3072 lds
    v_mfma_f32_32x32x16_bf16 v[240:255], v[116:119], a[236:239], v[240:255]
    ds_read_b64_tr_b16 v[126:127], v33 offset:5120
    s_waitcnt lgkmcnt(5)
    v_mfma_f32_32x32x16_bf16 v[128:143], v[120:123], a[240:243], v[128:143]
    ds_read_b64_tr_b16 v[112:113], v32 offset:8192
    s_waitcnt lgkmcnt(5)
    v_mfma_f32_32x32x16_bf16 v[144:159], v[120:123], a[244:247], v[144:159]
    ds_read_b64_tr_b16 v[114:115], v32 offset:9216
    s_waitcnt lgkmcnt(5)
    v_mfma_f32_32x32x16_bf16 v[160:175], v[120:123], a[248:251], v[160:175]
    ds_read_b128 a[224:227], v26 offset:32768
    s_mul_i32 s64, s69, 8320
    s_add_u32 s64, s64, s68
    s_add_u32 s57, s57, 4
    s_add_u32 m0, s64, 4240
    s_nop 0
    buffer_load_dwordx4 v4, s[32:35], s57 offen offset:0 lds
    s_waitcnt lgkmcnt(5)
    v_mfma_f32_32x32x16_bf16 v[176:191], v[120:123], a[252:255], v[176:191]
    ds_read_b128 a[228:231], v26 offset:36864
    s_waitcnt lgkmcnt(4)
    v_mfma_f32_32x32x16_bf16 v[192:207], v[124:127], a[240:243], v[192:207]
    ds_read_b128 a[232:235], v26 offset:40960
    buffer_load_dwordx3 v[60:62], v13, s[20:23], s66 offen offset:0 sc1
    v_mfma_f32_32x32x16_bf16 v[208:223], v[124:127], a[244:247], v[208:223]
    ds_read_b128 a[236:239], v26 offset:45056
    buffer_load_dwordx3 v[64:66], v13, s[20:23], s66 offen offset:512 sc1
    v_mfma_f32_32x32x16_bf16 v[224:239], v[124:127], a[248:251], v[224:239]
    ds_read_b64_tr_b16 v[116:117], v33 offset:8192
    buffer_load_dwordx3 v[68:70], v13, s[20:23], s75 offen offset:0 sc1
    buffer_load_dwordx4 v4, s[32:35], s57 offen offset:1024 lds
    v_mfma_f32_32x32x16_bf16 v[240:255], v[124:127], a[252:255], v[240:255]
    ds_read_b64_tr_b16 v[118:119], v33 offset:9216
    buffer_load_dwordx3 v[72:74], v13, s[20:23], s75 offen offset:512 sc1
    s_waitcnt lgkmcnt(5)
    v_mfma_f32_32x32x16_bf16 v[128:143], v[112:115], a[224:227], v[128:143]
    ds_read_b64_tr_b16 v[120:121], v32 offset:12288
    ds_read_b64_tr_b16 v[122:123], v32 offset:13312
    buffer_load_dwordx3 v[76:78], v13, s[20:23], s67 offen offset:0 sc1
    s_waitcnt lgkmcnt(6)
    v_mfma_f32_32x32x16_bf16 v[144:159], v[112:115], a[228:231], v[144:159]
    ds_read_b128 a[240:243], v27 offset:32768
    ds_read_b128 a[244:247], v27 offset:36864
    buffer_load_dwordx3 v[80:82], v13, s[20:23], s67 offen offset:512 sc1
    s_waitcnt lgkmcnt(7)
    v_mfma_f32_32x32x16_bf16 v[160:175], v[112:115], a[232:235], v[160:175]
    ds_read_b128 a[248:251], v27 offset:40960
    ds_read_b128 a[252:255], v27 offset:45056
    buffer_load_dwordx4 v[84:87], v13, s[20:23], s65 offen sc1
    s_waitcnt lgkmcnt(8)
    v_mfma_f32_32x32x16_bf16 v[176:191], v[112:115], a[236:239], v[176:191]
    ds_read_b64_tr_b16 v[124:125], v33 offset:12288
    ds_read_b64_tr_b16 v[126:127], v33 offset:13312
    s_add_u32 s50, s27, 0x20000
    s_mov_b64 exec, 0x7f
    buffer_load_dword a191, v5, s[20:23], s27 offen sc1
    buffer_load_dword a191, v5, s[20:23], s50 offen sc1
    s_mov_b64 exec, -1
    s_waitcnt lgkmcnt(8)
    v_mfma_f32_32x32x16_bf16 v[192:207], v[116:119], a[224:227], v[192:207]
    buffer_load_dwordx4 v4, s[32:35], s57 offen offset:2048 lds
    v_mfma_f32_32x32x16_bf16 v[208:223], v[116:119], a[228:231], v[208:223]
    v_mfma_f32_32x32x16_bf16 v[224:239], v[116:119], a[232:235], v[224:239]
    v_mfma_f32_32x32x16_bf16 v[240:255], v[116:119], a[236:239], v[240:255]
    s_waitcnt vmcnt(21) lgkmcnt(0)
    s_barrier
    v_mfma_f32_32x32x16_bf16 v[128:143], v[120:123], a[240:243], v[128:143]
    ds_read_b64_tr_b16 v[112:113], v34 offset:0
    buffer_load_dwordx4 v4, s[32:35], s57 offen offset:3072 lds
    v_accvgpr_read_b32 v32, a200
    v_mfma_f32_32x32x16_bf16 v[144:159], v[120:123], a[244:247], v[144:159]
    ds_read_b64_tr_b16 v[114:115], v34 offset:1024
    v_accvgpr_read_b32 v33, a201
    v_mfma_f32_32x32x16_bf16 v[160:175], v[120:123], a[248:251], v[160:175]
    ds_read_b128 a[224:227], v24 offset:49152
    v_mfma_f32_32x32x16_bf16 v[176:191], v[120:123], a[252:255], v[176:191]
    ds_read_b128 a[228:231], v24 offset:53248
    v_mfma_f32_32x32x16_bf16 v[192:207], v[124:127], a[240:243], v[192:207]
    ds_read_b64_tr_b16 v[116:117], v35 offset:0
    s_add_u32 m0, s56, 151552
    s_add_u32 s59, s1, 0
    s_sub_u32 s51, s59, 7
    s_cselect_b32 s59, s59, s51
    s_lshl_b32 s59, s59, 17
    buffer_load_dwordx4 v36, s[16:19], s59 offen offset:0 lds
    buffer_load_dwordx4 v37, s[16:19], s59 offen offset:1024 lds
    v_mfma_f32_32x32x16_bf16 v[208:223], v[124:127], a[244:247], v[208:223]
    ds_read_b64_tr_b16 v[118:119], v35 offset:1024
    buffer_load_dwordx4 v[48:51], v7, s[20:23], s71 offen offset:0 sc1
    buffer_load_dwordx4 v[52:55], v7, s[20:23], s71 offen offset:128 sc1
    buffer_load_dwordx4 v[56:59], v7, s[20:23], s71 offen offset:256 sc1
    v_mfma_f32_32x32x16_bf16 v[224:239], v[124:127], a[248:251], v[224:239]
    s_waitcnt vmcnt(22)
    s_mov_b32 exec_hi, 0
    ds_write_b32 v14, v11
    s_mov_b32 exec_hi, -1
    v_mfma_f32_32x32x16_bf16 v[240:255], v[124:127], a[252:255], v[240:255]
    ds_write_b128 v6, v[100:103]
    s_waitcnt lgkmcnt(5)
    v_mfma_f32_32x32x16_bf16 v[128:143], v[112:115], a[224:227], v[128:143]
    ds_read_b64_tr_b16 v[120:121], v34 offset:4096
    ds_read_b64_tr_b16 v[122:123], v34 offset:5120
    s_add_u32 m0, s56, 0
    s_add_u32 s59, s59, 16384
    buffer_load_dwordx4 v36, s[16:19], s59 offen offset:0 lds
    buffer_load_dwordx4 v37, s[16:19], s59 offen offset:1024 lds
    s_waitcnt lgkmcnt(6)
    v_mfma_f32_32x32x16_bf16 v[144:159], v[112:115], a[228:231], v[144:159]
    ds_read_b128 a[240:243], v25 offset:49152
    ds_read_b128 a[244:247], v25 offset:53248
    s_waitcnt lgkmcnt(6)
    v_mfma_f32_32x32x16_bf16 v[192:207], v[116:119], a[224:227], v[192:207]
    ds_read_b64_tr_b16 v[124:125], v35 offset:4096
    ds_read_b64_tr_b16 v[126:127], v35 offset:5120
    v_mfma_f32_32x32x16_bf16 v[208:223], v[116:119], a[228:231], v[208:223]
    s_cmp_lg_u32 s53, 7
    s_cbranch_scc1 L_xc_16
    ds_read_b64 a[216:217], v111 offset:49152
    v_xor_b32 v110, 16, v111
    ds_read_b64 a[218:219], v110 offset:49152
    v_xor_b32 v110, 32, v111
    ds_read_b64 a[220:221], v110 offset:49152
    v_xor_b32 v110, 48, v111
    ds_read_b64 a[222:223], v110 offset:49152
L_xc_16:
    s_waitcnt lgkmcnt(3)
    v_mfma_f32_32x32x16_bf16 v[128:143], v[120:123], a[240:243], v[128:143]
    ds_read_b64_tr_b16 v[112:113], v34 offset:8192
    ds_read_b64_tr_b16 v[114:115], v34 offset:9216
    s_add_u32 m0, s56, 8192
    s_add_u32 s59, s1, 1
    s_sub_u32 s51, s59, 7
    s_cselect_b32 s59, s59, s51
    s_lshl_b32 s59, s59, 17
    buffer_load_dwordx4 v36, s[16:19], s59 offen offset:0 lds
    buffer_load_dwordx4 v37, s[16:19], s59 offen offset:1024 lds
    s_waitcnt lgkmcnt(4)
    v_mfma_f32_32x32x16_bf16 v[144:159], v[120:123], a[244:247], v[144:159]
    ds_read_b128 a[224:227], v26 offset:49152
    ds_read_b128 a[228:231], v26 offset:53248
    s_waitcnt lgkmcnt(4)
    v_mfma_f32_32x32x16_bf16 v[192:207], v[124:127], a[240:243], v[192:207]
    ds_read_b64_tr_b16 v[116:117], v35 offset:8192
    ds_read_b64_tr_b16 v[118:119], v35 offset:9216
    v_mfma_f32_32x32x16_bf16 v[208:223], v[124:127], a[244:247], v[208:223]
    s_waitcnt lgkmcnt(3)
    v_mfma_f32_32x32x16_bf16 v[128:143], v[112:115], a[224:227], v[128:143]
    ds_read_b64_tr_b16 v[120:121], v34 offset:12288
    ds_read_b64_tr_b16 v[122:123], v34 offset:13312
    s_add_u32 m0, s56, 16384
    s_add_u32 s59, s59, 16384
    buffer_load_dwordx4 v36, s[16:19], s59 offen offset:0 lds
    buffer_load_dwordx4 v37, s[16:19], s59 offen offset:1024 lds
    s_waitcnt lgkmcnt(4)
    v_mfma_f32_32x32x16_bf16 v[144:159], v[112:115], a[228:231], v[144:159]
    ds_read_b128 a[240:243], v27 offset:49152
    ds_read_b128 a[244:247], v27 offset:53248
    s_waitcnt lgkmcnt(4)
    v_mfma_f32_32x32x16_bf16 v[192:207], v[116:119], a[224:227], v[192:207]
    ds_read_b64_tr_b16 v[124:125], v35 offset:12288
    ds_read_b64_tr_b16 v[126:127], v35 offset:13312
    v_mfma_f32_32x32x16_bf16 v[208:223], v[116:119], a[228:231], v[208:223]
    s_waitcnt vmcnt(15)
    v_xor_b32 v63, s48, v62
    v_bitop3_b32 v63, v66, s48, v63 bitop3:0xbe
    v_bitop3_b32 v63, v70, s48, v63 bitop3:0xbe
    v_bitop3_b32 v63, v74, s48, v63 bitop3:0xbe
    v_bitop3_b32 v63, v78, s48, v63 bitop3:0xbe
    v_bitop3_b32 v63, v82, s48, v63 bitop3:0xbe
    v_bitop3_b32 v63, v85, s48, v63 bitop3:0xbe
    v_bitop3_b32 v63, v87, s48, v63 bitop3:0xbe
    v_cmp_ne_u32 vcc, 0, v63
    s_or_b32 s74, vcc_lo, vcc_hi
    v_mov_b32 v44, v84
    v_mov_b32 v45, v86
    s_cmp_lg_u32 s74, 0
    s_cbranch_scc1 L_slow_corr_17
L_back_corr_18:
    s_nop 0
    v_mfma_f32_32x32x8_bf16 v[128:143], v[60:61], v[68:69], v[128:143]
    s_add_u32 m0, s56, 24576
    s_add_u32 s59, s1, 2
    s_sub_u32 s51, s59, 7
    s_cselect_b32 s59, s59, s51
    s_lshl_b32 s59, s59, 17
    buffer_load_dwordx4 v36, s[16:19], s59 offen offset:0 lds
    buffer_load_dwordx4 v37, s[16:19], s59 offen offset:1024 lds
    v_mfma_f32_32x32x8_bf16 v[144:159], v[60:61], v[72:73], v[144:159]
    v_mfma_f32_32x32x8_bf16 v[192:207], v[64:65], v[68:69], v[192:207]
    v_mfma_f32_32x32x8_bf16 v[208:223], v[64:65], v[72:73], v[208:223]
    s_waitcnt lgkmcnt(3)
    v_mfma_f32_32x32x16_bf16 v[128:143], v[120:123], a[240:243], v[128:143]
    ds_read_b64_tr_b16 v[112:113], v34 offset:0
    ds_read_b64_tr_b16 v[114:115], v34 offset:1024
    s_add_u32 m0, s56, 32768
    s_add_u32 s59, s59, 16384
    buffer_load_dwordx4 v36, s[16:19], s59 offen offset:0 lds
    buffer_load_dwordx4 v37, s[16:19], s59 offen offset:1024 lds
    s_waitcnt lgkmcnt(4)
    v_mfma_f32_32x32x16_bf16 v[144:159], v[120:123], a[244:247], v[144:159]
    ds_read_b128 a[224:227], v24 offset:57344
    ds_read_b128 a[228:231], v24 offset:61440
    s_waitcnt lgkmcnt(4)
    v_mfma_f32_32x32x16_bf16 v[192:207], v[124:127], a[240:243], v[192:207]
    ds_read_b64_tr_b16 v[116:117], v35 offset:0
    ds_read_b64_tr_b16 v[118:119], v35 offset:1024
    s_waitcnt vmcnt(10)
    v_xor_b32 v92, s48, v51
    v_bitop3_b32 v92, v55, s48, v92 bitop3:0xbe
    v_mfma_f32_32x32x16_bf16 v[208:223], v[124:127], a[244:247], v[208:223]
    v_bitop3_b32 v92, v59, s48, v92 bitop3:0xbe
    v_cmp_ne_u32 vcc, 0, v92
    s_or_b32 s73, vcc_lo, vcc_hi
    v_mov_b32 v51, v56
    v_mov_b32 v55, v57
    v_mfma_f32_32x32x8_bf16 v[160:175], v[60:61], v[76:77], v[160:175]
    s_add_u32 m0, s56, 40960
    s_add_u32 s59, s1, 3
    s_sub_u32 s51, s59, 7
    s_cselect_b32 s59, s59, s51
    s_lshl_b32 s59, s59, 17
    buffer_load_dwordx4 v36, s[16:19], s59 offen offset:0 lds
    buffer_load_dwordx4 v37, s[16:19], s59 offen offset:1024 lds
    v_mfma_f32_32x32x8_bf16 v[176:191], v[60:61], v[80:81], v[176:191]
    v_max_f32 v128, 0, v128
    v_max_f32 v129, 0, v129
    v_max_f32 v130, 0, v130
    v_max_f32 v131, 0, v131
    v_max_f32 v132, 0, v132
    v_mfma_f32_32x32x8_bf16 v[224:239], v[64:65], v[76:77], v[224:239]
    v_max_f32 v133, 0, v133
    v_max_f32 v134, 0, v134
    v_max_f32 v135, 0, v135
    v_mul_f32 v128, v128, v136
    v_mul_f32 v129, v129, v137
    v_mfma_f32_32x32x8_bf16 v[240:255], v[64:65], v[80:81], v[240:255]
    v_mul_f32 v130, v130, v138
    v_mul_f32 v131, v131, v139
    v_mul_f32 v132, v132, v140
    v_mul_f32 v133, v133, v141
    v_mul_f32 v134, v134, v142
    s_waitcnt lgkmcnt(3)
    v_mfma_f32_32x32x16_bf16 v[160:175], v[112:115], a[224:227], v[160:175]
    ds_read_b64_tr_b16 v[120:121], v34 offset:4096
    ds_read_b64_tr_b16 v[122:123], v34 offset:5120
    v_mul_f32 v135, v135, v143
    v_cvt_pk_bf16_f32 v60, v128, v129
    v_cvt_pk_bf16_f32 v61, v130, v131
    s_waitcnt lgkmcnt(4)
    v_mfma_f32_32x32x16_bf16 v[176:191], v[112:115], a[228:231], v[176:191]
    ds_read_b128 a[240:243], v25 offset:57344
    ds_read_b128 a[244:247], v25 offset:61440
    v_cvt_pk_bf16_f32 v62, v132, v133
    v_cvt_pk_bf16_f32 v63, v134, v135
    v_max_f32 v144, 0, v144
    s_waitcnt lgkmcnt(4)
    v_mfma_f32_32x32x16_bf16 v[224:239], v[116:119], a[224:227], v[224:239]
    ds_read_b64_tr_b16 v[124:125], v35 offset:4096
    ds_read_b64_tr_b16 v[126:127], v35 offset:5120
    buffer_store_dwordx4 v[60:63], v4, s[20:23], s24 offen offset:0 sc1
    v_mfma_f32_32x32x16_bf16 v[240:255], v[116:119], a[228:231], v[240:255]
    v_max_f32 v145, 0, v145
    v_max_f32 v146, 0, v146
    v_max_f32 v147, 0, v147
    v_max_f32 v148, 0, v148
    v_max_f32 v149, 0, v149
    s_waitcnt lgkmcnt(3)
    v_mfma_f32_32x32x16_bf16 v[160:175], v[120:123], a[240:243], v[160:175]
    ds_read_b64_tr_b16 v[112:113], v34 offset:8192
    ds_read_b64_tr_b16 v[114:115], v34 offset:9216
    v_max_f32 v150, 0, v150
    v_max_f32 v151, 0, v151
    v_mul_f32 v144, v144, v152
    s_waitcnt lgkmcnt(4)
    v_mfma_f32_32x32x16_bf16 v[176:191], v[120:123], a[244:247], v[176:191]
    ds_read_b128 a[224:227], v26 offset:57344
    ds_read_b128 a[228:231], v26 offset:61440
    v_mul_f32 v145, v145, v153
    v_mul_f32 v146, v146, v154
    v_mul_f32 v147, v147, v155
    s_waitcnt lgkmcnt(4)
    v_mfma_f32_32x32x16_bf16 v[224:239], v[124:127], a[240:243], v[224:239]
    ds_read_b64_tr_b16 v[116:117], v35 offset:8192
    ds_read_b64_tr_b16 v[118:119], v35 offset:9216
    v_mul_f32 v148, v148, v156
    v_mul_f32 v149, v149, v157
    v_mul_f32 v150, v150, v158
    v_mfma_f32_32x32x16_bf16 v[240:255], v[124:127], a[244:247], v[240:255]
    v_mul_f32 v151, v151, v159
    v_cvt_pk_bf16_f32 v68, v144, v145
    v_cvt_pk_bf16_f32 v69, v146, v147
    v_cvt_pk_bf16_f32 v70, v148, v149
    v_cvt_pk_bf16_f32 v71, v150, v151
    s_waitcnt lgkmcnt(3)
    v_mfma_f32_32x32x16_bf16 v[160:175], v[112:115], a[224:227], v[160:175]
    ds_read_b64_tr_b16 v[120:121], v34 offset:12288
    ds_read_b64_tr_b16 v[122:123], v34 offset:13312
    ds_read_b128 a[240:243], v27 offset:57344
    v_max_f32 v192, 0, v192
    v_max_f32 v193, 0, v193
    s_waitcnt lgkmcnt(5)
    v_mfma_f32_32x32x16_bf16 v[176:191], v[112:115], a[228:231], v[176:191]
    ds_read_b128 a[244:247], v27 offset:61440
    ds_read_b64_tr_b16 v[124:125], v35 offset:12288
    ds_read_b64_tr_b16 v[126:127], v35 offset:13312
    s_add_u32 s67, s24, 114688
    buffer_store_dwordx4 v[68:71], v4, s[20:23], s67 offen offset:0 sc1
    s_waitcnt lgkmcnt(6)
    v_mfma_f32_32x32x16_bf16 v[224:239], v[116:119], a[224:227], v[224:239]
    v_max_f32 v194, 0, v194
    v_max_f32 v195, 0, v195
    v_max_f32 v196, 0, v196
    v_max_f32 v197, 0, v197
    v_max_f32 v198, 0, v198
    v_mfma_f32_32x32x16_bf16 v[240:255], v[116:119], a[228:231], v[240:255]
    v_max_f32 v199, 0, v199
    v_mul_f32 v192, v192, v200
    v_mul_f32 v193, v193, v201
    v_mul_f32 v194, v194, v202
    v_mul_f32 v195, v195, v203
    ds_write_b128 v15, v[48:51] offset:4576
    v_alignbit_b32 v92, v49, v48, 16
    v_alignbit_b32 v93, v50, v49, 16
    v_alignbit_b32 v94, v51, v50, 16
    v_alignbit_b32 v95, v58, v51, 16
    ds_write_b128 v15, v[92:95] offset:0
    ds_write_b128 v15, v[52:55] offset:13728
    v_alignbit_b32 v96, v53, v52, 16
    v_alignbit_b32 v97, v54, v53, 16
    v_alignbit_b32 v98, v55, v54, 16
    v_perm_b32 v99, v58, v55, s70
    ds_write_b128 v15, v[96:99] offset:9152
    s_cmp_lg_u32 s73, 0
    s_cbranch_scc1 L_slow_u_21
L_back_u_22:
    s_waitcnt lgkmcnt(0)
    s_barrier
    v_mfma_f32_32x32x16_bf16 v[160:175], v[120:123], a[240:243], v[160:175]
    ds_read_b128 a[112:115], v41 offset:3584
    ds_read_b128 a[116:119], v42 offset:0
    ds_read_b128 a[120:123], v41 offset:3072
    ds_read_b128 a[124:127], v42 offset:512
    v_mul_f32 v196, v196, v204
    v_mfma_f32_32x32x16_bf16 v[176:191], v[120:123], a[244:247], v[176:191]
    ds_read_b128 a[128:131], v41 offset:2560
    ds_read_b128 a[132:135], v42 offset:1024
    ds_read_b128 a[136:139], v41 offset:2048
    ds_read_b128 a[140:143], v42 offset:1536
    v_mul_f32 v197, v197, v205
    v_mfma_f32_32x32x16_bf16 v[224:239], v[124:127], a[240:243], v[224:239]
    ds_read_b128 a[144:147], v41 offset:1536
    ds_read_b128 a[148:151], v42 offset:2048
    ds_read_b128 a[152:155], v41 offset:1024
    ds_read_b128 a[156:159], v42 offset:2560
    v_mul_f32 v198, v198, v206
    v_mfma_f32_32x32x16_bf16 v[240:255], v[124:127], a[244:247], v[240:255]
    ds_read_b128 a[160:163], v41 offset:512
    ds_read_b128 a[164:167], v42 offset:3072
    ds_read_b128 a[168:171], v41 offset:0
    ds_read_b128 a[172:175], v42 offset:3584
    v_mul_f32 v199, v199, v207
    s_waitcnt lgkmcnt(14)
    v_mfma_f32_16x16x32_bf16 v[96:99], a[112:115], a[116:119], 0
    s_mov_b32 s8, s20
    s_mov_b32 s9, s21
    v_mov_b32 v43, s48
    v_mov_b32 v8, s48
    s_waitcnt lgkmcnt(12)
    v_mfma_f32_16x16x32_bf16 v[100:103], a[112:115], a[124:127], 0
    v_cvt_pk_bf16_f32 v64, v192, v193
    v_cvt_pk_bf16_f32 v65, v194, v195
    v_cvt_pk_bf16_f32 v66, v196, v197
    v_cvt_pk_bf16_f32 v67, v198, v199
    v_mfma_f32_16x16x32_bf16 v[100:103], a[120:123], a[116:119], v[100:103]
    v_max_f32 v208, 0, v208
    v_max_f32 v209, 0, v209
    v_max_f32 v210, 0, v210
    v_max_f32 v211, 0, v211
    v_mfma_f32_16x16x32_bf16 v[104:107], a[120:123], a[124:127], 0
    ds_read_b128 a[176:179], v41 offset:3648
    buffer_store_dwordx4 v[64:67], v4, s[20:23], s24 offen offset:1024 sc1
    s_waitcnt lgkmcnt(11)
    v_mfma_f32_16x16x32_bf16 v[104:107], a[112:115], a[132:135], v[104:107]
    v_max_f32 v212, 0, v212
    v_max_f32 v213, 0, v213
    v_max_f32 v214, 0, v214
    v_max_f32 v215, 0, v215
    v_mfma_f32_16x16x32_bf16 v[104:107], a[128:131], a[116:119], v[104:107]
    ds_read_b128 a[180:183], v42 offset:64
    v_mul_f32 v208, v208, v216
    v_mul_f32 v209, v209, v217
    v_mul_f32 v210, v210, v218
    v_mfma_f32_16x16x32_bf16 v[108:111], a[120:123], a[132:135], 0
    v_mul_f32 v211, v211, v219
    v_mul_f32 v212, v212, v220
    v_mul_f32 v213, v213, v221
    v_mul_f32 v214, v214, v222
    v_mfma_f32_16x16x32_bf16 v[108:111], a[128:131], a[124:127], v[108:111]
    ds_read_b128 a[184:187], v41 offset:3136
    v_mul_f32 v215, v215, v223
    v_cvt_pk_bf16_f32 v72, v208, v209
    v_cvt_pk_bf16_f32 v73, v210, v211
    v_mfma_f32_16x16x32_bf16 v[112:115], a[128:131], a[132:135], 0
    v_cvt_pk_bf16_f32 v74, v212, v213
    v_cvt_pk_bf16_f32 v75, v214, v215
    v_max_f32 v160, 0, v160
    v_max_f32 v161, 0, v161
    s_waitcnt lgkmcnt(11)
    v_mfma_f32_16x16x32_bf16 v[108:111], a[112:115], a[140:143], v[108:111]
    ds_read_b128 a[188:191], v42 offset:576
    s_add_u32 s67, s24, 114688
    buffer_store_dwordx4 v[72:75], v4, s[20:23], s67 offen offset:1024 sc1
    v_mfma_f32_16x16x32_bf16 v[108:111], a[136:139], a[116:119], v[108:111]
    v_max_f32 v162, 0, v162
    v_max_f32 v163, 0, v163
    v_max_f32 v164, 0, v164
    v_max_f32 v165, 0, v165
    v_mfma_f32_16x16x32_bf16 v[112:115], a[120:123], a[140:143], v[112:115]
    v_accvgpr_read_b32 v34, a202
    v_accvgpr_read_b32 v35, a203
    v_accvgpr_read_b32 v12, a208
    v_accvgpr_read_b32 v13, a209
    ds_read_b128 a[192:195], v41 offset:2624
    v_max_f32 v166, 0, v166
    v_max_f32 v167, 0, v167
    v_mul_f32 v160, v160, v168
    v_mfma_f32_16x16x32_bf16 v[112:115], a[136:139], a[124:127], v[112:115]
    v_mul_f32 v161, v161, v169
    v_mul_f32 v162, v162, v170
    v_mul_f32 v163, v163, v171
    v_mul_f32 v164, v164, v172
    v_mfma_f32_16x16x32_bf16 v[116:119], a[128:131], a[140:143], 0
    ds_read_b128 a[196:199], v42 offset:1088
    v_mul_f32 v165, v165, v173
    v_mul_f32 v166, v166, v174
    v_mul_f32 v167, v167, v175
    v_mfma_f32_16x16x32_bf16 v[116:119], a[136:139], a[132:135], v[116:119]
    v_cvt_pk_bf16_f32 v76, v160, v161
    v_cvt_pk_bf16_f32 v77, v162, v163
    v_cvt_pk_bf16_f32 v78, v164, v165
    v_cvt_pk_bf16_f32 v79, v166, v167
    v_mfma_f32_16x16x32_bf16 v[120:123], a[136:139], a[140:143], 0
    ds_read_b128 a[200:203], v41 offset:2112
    v_max_f32 v176, 0, v176
    v_max_f32 v177, 0, v177
    v_max_f32 v178, 0, v178
    s_waitcnt lgkmcnt(13)
    v_mfma_f32_16x16x32_bf16 v[112:115], a[112:115], a[148:151], v[112:115]
    buffer_store_dwordx4 v[76:79], v4, s[20:23], s25 offen offset:0 sc1
    v_max_f32 v179, 0, v179
    v_mfma_f32_16x16x32_bf16 v[112:115], a[144:147], a[116:119], v[112:115]
    ds_read_b128 a[204:207], v42 offset:1600
    v_max_f32 v180, 0, v180
    v_max_f32 v181, 0, v181
    v_max_f32 v182, 0, v182
    v_mfma_f32_16x16x32_bf16 v[116:119], a[120:123], a[148:151], v[116:119]
    v_max_f32 v183, 0, v183
    v_mul_f32 v176, v176, v184
    v_mul_f32 v177, v177, v185
    v_mul_f32 v178, v178, v186
    v_mfma_f32_16x16x32_bf16 v[116:119], a[144:147], a[124:127], v[116:119]
    ds_read_b128 a[208:211], v41 offset:1600
    v_mul_f32 v179, v179, v187
    v_mul_f32 v180, v180, v188
    v_mul_f32 v181, v181, v189
    v_mfma_f32_16x16x32_bf16 v[120:123], a[128:131], a[148:151], v[120:123]
    v_mul_f32 v182, v182, v190
    v_mul_f32 v183, v183, v191
    v_cvt_pk_bf16_f32 v84, v176, v177
    v_cvt_pk_bf16_f32 v85, v178, v179
    v_mfma_f32_16x16x32_bf16 v[120:123], a[144:147], a[132:135], v[120:123]
    ds_read_b128 a[212:215], v42 offset:2112
    v_cvt_pk_bf16_f32 v86, v180, v181
    v_cvt_pk_bf16_f32 v87, v182, v183
    v_max_f32 v224, 0, v224
    v_mfma_f32_16x16x32_bf16 v[124:127], a[136:139], a[148:151], 0
    s_add_u32 s67, s25, 114688
    buffer_store_dwordx4 v[84:87], v4, s[20:23], s67 offen offset:0 sc1
    v_mfma_f32_16x16x32_bf16 v[124:127], a[144:147], a[140:143], v[124:127]
    ds_read_b128 a[224:227], v41 offset:1088
    v_max_f32 v225, 0, v225
    v_max_f32 v226, 0, v226
    v_max_f32 v227, 0, v227
    s_waitcnt lgkmcnt(15)
    v_mfma_f32_16x16x32_bf16 v[116:119], a[112:115], a[156:159], v[116:119]
    v_max_f32 v228, 0, v228
    v_max_f32 v229, 0, v229
    v_max_f32 v230, 0, v230
    v_max_f32 v231, 0, v231
    v_mfma_f32_16x16x32_bf16 v[116:119], a[152:155], a[116:119], v[116:119]
    ds_read_b128 a[228:231], v42 offset:2624
    v_mul_f32 v224, v224, v232
    v_mul_f32 v225, v225, v233
    v_mul_f32 v226, v226, v234
    v_mfma_f32_16x16x32_bf16 v[120:123], a[120:123], a[156:159], v[120:123]
    s_waitcnt vmcnt(2)
    s_mov_b32 exec_hi, 0
    buffer_store_dword v3, v2, s[20:23], s26 offen sc1
    s_mov_b32 exec_hi, -1
    v_mfma_f32_16x16x32_bf16 v[120:123], a[152:155], a[124:127], v[120:123]
    ds_read_b128 a[232:235], v41 offset:576
    v_mul_f32 v227, v227, v235
    v_mul_f32 v228, v228, v236
    v_mul_f32 v229, v229, v237
    v_mfma_f32_16x16x32_bf16 v[124:127], a[128:131], a[156:159], v[124:127]
    v_mul_f32 v230, v230, v238
    v_mul_f32 v231, v231, v239
    v_cvt_pk_bf16_f32 v80, v224, v225
    v_cvt_pk_bf16_f32 v81, v226, v227
    v_mfma_f32_16x16x32_bf16 v[124:127], a[152:155], a[132:135], v[124:127]
    ds_read_b128 a[236:239], v42 offset:3136
    v_cvt_pk_bf16_f32 v82, v228, v229
    v_cvt_pk_bf16_f32 v83, v230, v231
    v_max_f32 v240, 0, v240
    s_waitcnt lgkmcnt(15)
    v_mfma_f32_16x16x32_bf16 v[120:123], a[112:115], a[164:167], v[120:123]
    buffer_store_dwordx4 v[80:83], v4, s[20:23], s25 offen offset:1024 sc1
    v_max_f32 v241, 0, v241
    v_mfma_f32_16x16x32_bf16 v[120:123], a[160:163], a[116:119], v[120:123]
    ds_read_b128 a[240:243], v41 offset:64
    v_max_f32 v242, 0, v242
    v_max_f32 v243, 0, v243
    v_max_f32 v244, 0, v244
    v_mfma_f32_16x16x32_bf16 v[124:127], a[120:123], a[164:167], v[124:127]
    v_max_f32 v245, 0, v245
    v_max_f32 v246, 0, v246
    v_max_f32 v247, 0, v247
    v_mul_f32 v240, v240, v248
    v_mfma_f32_16x16x32_bf16 v[124:127], a[160:163], a[124:127], v[124:127]
    ds_read_b128 a[244:247], v42 offset:3648
    v_mul_f32 v241, v241, v249
    v_mul_f32 v242, v242, v250
    v_mul_f32 v243, v243, v251
    s_waitcnt lgkmcnt(15)
    v_mfma_f32_16x16x32_bf16 v[124:127], a[112:115], a[172:175], v[124:127]
    v_mul_f32 v244, v244, v252
    v_mul_f32 v245, v245, v253
    v_mul_f32 v246, v246, v254
    v_mul_f32 v247, v247, v255
    v_mfma_f32_16x16x32_bf16 v[124:127], a[168:171], a[116:119], v[124:127]
    v_cvt_pk_bf16_f32 v88, v240, v241
    v_cvt_pk_bf16_f32 v89, v242, v243
    v_cvt_pk_bf16_f32 v90, v244, v245
    v_cvt_pk_bf16_f32 v91, v246, v247
    v_mfma_f32_16x16x32_bf16 v[96:99], a[112:115], a[108:111], v[96:99]
    ds_read_b64_tr_b16 a[0:1], v38 offset:53248
    ds_read_b64_tr_b16 a[2:3], v38 offset:54272
    ds_read_b64_tr_b16 a[4:5], v39 offset:53248
    ds_read_b64_tr_b16 a[6:7], v39 offset:54272
    v_mfma_f32_16x16x32_bf16 v[100:103], a[120:123], a[108:111], v[100:103]
    s_add_u32 s67, s25, 114688
    buffer_store_dwordx4 v[88:91], v4, s[20:23], s67 offen offset:1024 sc1
    v_mfma_f32_16x16x32_bf16 v[104:107], a[128:131], a[108:111], v[104:107]
    s_waitcnt lgkmcnt(0)
    s_add_u32 m0, s56, 151552
    s_add_u32 s59, s59, 16384
    buffer_load_dwordx4 v36, s[16:19], s59 offen offset:0 lds
    buffer_load_dwordx4 v37, s[16:19], s59 offen offset:1024 lds
    v_mfma_f32_16x16x32_bf16 v[108:111], a[136:139], a[108:111], v[108:111]
    ds_read_b64_tr_b16 a[8:9], v46 offset:0
    ds_read_b64_tr_b16 a[10:11], v46 offset:1024
    ds_read_b64_tr_b16 a[12:13], v47 offset:0
    ds_read_b64_tr_b16 a[14:15], v47 offset:1024
    v_mfma_f32_16x16x32_bf16 v[112:115], a[144:147], a[108:111], v[112:115]
    ds_read_b64_tr_b16 a[16:17], v46 offset:8192
    ds_read_b64_tr_b16 a[18:19], v46 offset:9216
    ds_read_b64_tr_b16 a[20:21], v47 offset:8192
    ds_read_b64_tr_b16 a[22:23], v47 offset:9216
    v_mfma_f32_16x16x32_bf16 v[116:119], a[152:155], a[108:111], v[116:119]
    ds_read_b64_tr_b16 a[24:25], v46 offset:16384
    ds_read_b64_tr_b16 a[26:27], v46 offset:17408
    ds_read_b64_tr_b16 a[28:29], v47 offset:16384
    ds_read_b64_tr_b16 a[30:31], v47 offset:17408
    v_mfma_f32_16x16x32_bf16 v[120:123], a[160:163], a[108:111], v[120:123]
    s_cmp_lg_u32 s0, 0
    s_cbranch_scc1 L_hsw_25
    v_swap_b32 v60, v68
    v_swap_b32 v61, v69
    v_swap_b32 v62, v70
    v_swap_b32 v63, v71
    v_swap_b32 v64, v72
    v_swap_b32 v65, v73
    v_swap_b32 v66, v74
    v_swap_b32 v67, v75
    v_swap_b32 v76, v84
    v_swap_b32 v77, v85
    v_swap_b32 v78, v86
    v_swap_b32 v79, v87
    v_swap_b32 v80, v88
    v_swap_b32 v81, v89
    v_swap_b32 v82, v90
    v_swap_b32 v83, v91
L_hsw_25:
    v_mfma_f32_16x16x32_bf16 v[124:127], a[168:171], a[108:111], v[124:127]
    ds_read_b64_tr_b16 a[32:33], v46 offset:24576
    ds_read_b64_tr_b16 a[34:35], v46 offset:25600
    ds_read_b64_tr_b16 a[36:37], v47 offset:24576
    ds_read_b64_tr_b16 a[38:39], v47 offset:25600
    v_mfma_f32_16x16x32_bf16 v[96:99], a[176:179], a[180:183], v[96:99]
    ds_read_b64_tr_b16 a[40:41], v46 offset:32768
    v_mfma_f32_16x16x32_bf16 v[100:103], a[176:179], a[188:191], v[100:103]
    s_add_u32 m0, s56, 49152
    s_add_u32 s59, s1, 4
    s_sub_u32 s51, s59, 7
    s_cselect_b32 s59, s59, s51
    s_lshl_b32 s59, s59, 17
    buffer_load_dwordx4 v36, s[16:19], s59 offen offset:0 lds
    buffer_load_dwordx4 v37, s[16:19], s59 offen offset:1024 lds
    v_mfma_f32_16x16x32_bf16 v[100:103], a[184:187], a[180:183], v[100:103]
    ds_read_b64_tr_b16 a[42:43], v46 offset:33792
    v_mfma_f32_16x16x32_bf16 v[104:107], a[184:187], a[188:191], v[104:107]
    ds_read_b128 a[112:115], v41 offset:3712
    v_mfma_f32_16x16x32_bf16 v[104:107], a[176:179], a[196:199], v[104:107]
    ds_read_b64_tr_b16 a[44:45], v47 offset:32768
    v_mfma_f32_16x16x32_bf16 v[104:107], a[192:195], a[180:183], v[104:107]
    ds_read_b128 a[116:119], v42 offset:128
    v_mfma_f32_16x16x32_bf16 v[108:111], a[184:187], a[196:199], v[108:111]
    ds_read_b64_tr_b16 a[46:47], v47 offset:33792
    v_mfma_f32_16x16x32_bf16 v[108:111], a[192:195], a[188:191], v[108:111]
    ds_read_b128 a[120:123], v41 offset:3200
    v_mfma_f32_16x16x32_bf16 v[112:115], a[192:195], a[196:199], v[112:115]
    ds_read_b64_tr_b16 a[48:49], v46 offset:40960
    v_mfma_f32_16x16x32_bf16 v[108:111], a[176:179], a[204:207], v[108:111]
    ds_read_b128 a[124:127], v42 offset:640
    v_mfma_f32_16x16x32_bf16 v[108:111], a[200:203], a[180:183], v[108:111]
    s_add_u32 m0, s56, 57344
    s_add_u32 s59, s59, 16384
    buffer_load_dwordx4 v36, s[16:19], s59 offen offset:0 lds
    buffer_load_dwordx4 v37, s[16:19], s59 offen offset:1024 lds
    v_mfma_f32_16x16x32_bf16 v[112:115], a[184:187], a[204:207], v[112:115]
    ds_read_b128 a[128:131], v41 offset:2688
    v_mfma_f32_16x16x32_bf16 v[112:115], a[200:203], a[188:191], v[112:115]
    ds_read_b64_tr_b16 a[50:51], v46 offset:41984
    v_mfma_f32_16x16x32_bf16 v[116:119], a[192:195], a[204:207], v[116:119]
    ds_read_b128 a[132:135], v42 offset:1152
    v_mfma_f32_16x16x32_bf16 v[116:119], a[200:203], a[196:199], v[116:119]
    ds_read_b64_tr_b16 a[52:53], v47 offset:40960
    v_mfma_f32_16x16x32_bf16 v[120:123], a[200:203], a[204:207], v[120:123]
    ds_read_b128 a[136:139], v41 offset:2176
    v_mfma_f32_16x16x32_bf16 v[112:115], a[176:179], a[212:215], v[112:115]
    ds_read_b64_tr_b16 a[54:55], v47 offset:41984
    v_mfma_f32_16x16x32_bf16 v[112:115], a[208:211], a[180:183], v[112:115]
    ds_read_b128 a[140:143], v42 offset:1664
    v_mfma_f32_16x16x32_bf16 v[116:119], a[184:187], a[212:215], v[116:119]
    s_waitcnt lgkmcnt(15)
    s_add_u32 m0, s56, 0
    s_add_u32 s59, s1, 5
    s_sub_u32 s51, s59, 7
    s_cselect_b32 s59, s59, s51
    s_lshl_b32 s59, s59, 17
    buffer_load_dwordx4 v36, s[16:19], s59 offen offset:0 lds
    buffer_load_dwordx4 v37, s[16:19], s59 offen offset:1024 lds
    v_mfma_f32_16x16x32_bf16 v[116:119], a[208:211], a[188:191], v[116:119]
    ds_read_b128 a[144:147], v41 offset:1664
    v_mfma_f32_16x16x32_bf16 v[120:123], a[192:195], a[212:215], v[120:123]
    v_mov_b32 v51, s48
    v_mfma_f32_16x16x32_bf16 v[120:123], a[208:211], a[196:199], v[120:123]
    ds_read_b128 a[148:151], v42 offset:2176
    v_mfma_f32_16x16x32_bf16 v[124:127], a[200:203], a[212:215], v[124:127]
    v_mov_b32 v55, s48
    v_mfma_f32_16x16x32_bf16 v[124:127], a[208:211], a[204:207], v[124:127]
    ds_read_b128 a[152:155], v41 offset:1152
    v_mfma_f32_16x16x32_bf16 v[116:119], a[176:179], a[228:231], v[116:119]
    v_mov_b32 v58, s48
    v_mfma_f32_16x16x32_bf16 v[116:119], a[224:227], a[180:183], v[116:119]
    ds_read_b128 a[156:159], v42 offset:2688
    v_mfma_f32_16x16x32_bf16 v[120:123], a[184:187], a[228:231], v[120:123]
    s_add_u32 m0, s56, 8192
    s_add_u32 s59, s59, 16384
    buffer_load_dwordx4 v36, s[16:19], s59 offen offset:0 lds
    buffer_load_dwordx4 v37, s[16:19], s59 offen offset:1024 lds
    v_mfma_f32_16x16x32_bf16 v[120:123], a[224:227], a[188:191], v[120:123]
    ds_read_b128 a[160:163], v41 offset:640
    v_mfma_f32_16x16x32_bf16 v[124:127], a[192:195], a[228:231], v[124:127]
    v_mov_b32 v59, s48
    v_mfma_f32_16x16x32_bf16 v[124:127], a[224:227], a[196:199], v[124:127]
    ds_read_b128 a[164:167], v42 offset:3200
    v_mfma_f32_16x16x32_bf16 v[120:123], a[176:179], a[236:239], v[120:123]
    v_mfma_f32_16x16x32_bf16 v[120:123], a[232:235], a[180:183], v[120:123]
    ds_read_b128 a[168:171], v41 offset:128
    v_mfma_f32_16x16x32_bf16 v[124:127], a[184:187], a[236:239], v[124:127]
    v_mfma_f32_16x16x32_bf16 v[124:127], a[232:235], a[188:191], v[124:127]
    ds_read_b128 a[172:175], v42 offset:3712
    v_mfma_f32_16x16x32_bf16 v[124:127], a[176:179], a[244:247], v[124:127]
    s_add_u32 m0, s56, 16384
    s_add_u32 s59, s1, 6
    s_sub_u32 s51, s59, 7
    s_cselect_b32 s59, s59, s51
    s_lshl_b32 s59, s59, 17
    buffer_load_dwordx4 v36, s[16:19], s59 offen offset:0 lds
    buffer_load_dwordx4 v37, s[16:19], s59 offen offset:1024 lds
    v_mfma_f32_16x16x32_bf16 v[124:127], a[240:243], a[180:183], v[124:127]
    s_mov_b64 exec, 0x7f
    buffer_load_dword v43, v5, s[20:23], s27 offen sc1
    s_mov_b64 exec, -1
    s_waitcnt lgkmcnt(15)
    v_mfma_f32_16x16x32_bf16 v[96:99], a[112:115], a[116:119], v[96:99]
    v_mfma_f32_16x16x32_bf16 v[100:103], a[112:115], a[124:127], v[100:103]
    v_mfma_f32_16x16x32_bf16 v[100:103], a[120:123], a[116:119], v[100:103]
    v_mfma_f32_16x16x32_bf16 v[104:107], a[120:123], a[124:127], v[104:107]
    ds_read_b128 a[176:179], v41 offset:3776
    s_waitcnt lgkmcnt(13)
    v_mfma_f32_16x16x32_bf16 v[104:107], a[112:115], a[132:135], v[104:107]
    s_waitcnt vmcnt(13)
    s_add_u32 s26, s26, 0x20000
    s_mov_b32 exec_hi, 0
    buffer_store_dword v3, v2, s[20:23], s26 offen sc1
    s_mov_b32 exec_hi, -1
    v_mfma_f32_16x16x32_bf16 v[104:107], a[128:131], a[116:119], v[104:107]
    ds_read_b128 a[180:183], v42 offset:192
    v_mfma_f32_16x16x32_bf16 v[108:111], a[120:123], a[132:135], v[108:111]
    s_add_u32 m0, s56, 24576
    s_add_u32 s59, s59, 16384
    buffer_load_dwordx4 v36, s[16:19], s59 offen offset:0 lds
    buffer_load_dwordx4 v37, s[16:19], s59 offen offset:1024 lds
    v_mfma_f32_16x16x32_bf16 v[108:111], a[128:131], a[124:127], v[108:111]
    ds_read_b128 a[184:187], v41 offset:3264
    v_mfma_f32_16x16x32_bf16 v[112:115], a[128:131], a[132:135], v[112:115]
    s_waitcnt lgkmcnt(11)
    v_mfma_f32_16x16x32_bf16 v[108:111], a[112:115], a[140:143], v[108:111]
    ds_read_b128 a[188:191], v42 offset:704
    v_mfma_f32_16x16x32_bf16 v[108:111], a[136:139], a[116:119], v[108:111]
    v_mfma_f32_16x16x32_bf16 v[112:115], a[120:123], a[140:143], v[112:115]
    ds_read_b128 a[192:195], v41 offset:2752
    v_mfma_f32_16x16x32_bf16 v[112:115], a[136:139], a[124:127], v[112:115]
    v_mfma_f32_16x16x32_bf16 v[116:119], a[128:131], a[140:143], v[116:119]
    ds_read_b128 a[196:199], v42 offset:1216
    v_mfma_f32_16x16x32_bf16 v[116:119], a[136:139], a[132:135], v[116:119]
    v_mfma_f32_16x16x32_bf16 v[120:123], a[136:139], a[140:143], v[120:123]
    ds_read_b128 a[200:203], v41 offset:2240
    s_waitcnt lgkmcnt(13)
    v_mfma_f32_16x16x32_bf16 v[112:115], a[112:115], a[148:151], v[112:115]
    v_mfma_f32_16x16x32_bf16 v[112:115], a[144:147], a[116:119], v[112:115]
    ds_read_b128 a[204:207], v42 offset:1728
    v_mfma_f32_16x16x32_bf16 v[116:119], a[120:123], a[148:151], v[116:119]
    v_mfma_f32_16x16x32_bf16 v[116:119], a[144:147], a[124:127], v[116:119]
    ds_read_b128 a[208:211], v41 offset:1728
    v_mfma_f32_16x16x32_bf16 v[120:123], a[128:131], a[148:151], v[120:123]
    s_waitcnt vmcnt(3)
    v_cmp_ne_u32 vcc, s48, v43
    s_or_b32 s75, vcc_lo, vcc_hi
    s_cselect_b32 s10, 0, 33554432
    v_mfma_f32_16x16x32_bf16 v[120:123], a[144:147], a[132:135], v[120:123]
    ds_read_b128 a[212:215], v42 offset:2240
    v_mfma_f32_16x16x32_bf16 v[124:127], a[136:139], a[148:151], v[124:127]
    s_cmp_lg_u32 s75, 0
    s_cbranch_scc1 L_slow_h2_26
L_back_h2_27:
    buffer_load_dwordx4 v[192:195], v28, s[8:11], s28 offen offset:0 sc1
    v_mfma_f32_16x16x32_bf16 v[124:127], a[144:147], a[140:143], v[124:127]
    ds_read_b128 a[224:227], v41 offset:1216
    s_waitcnt lgkmcnt(15)
    v_mfma_f32_16x16x32_bf16 v[116:119], a[112:115], a[156:159], v[116:119]
    ds_read_b64_tr_b16 a[64:65], v46 offset:49152
    v_mfma_f32_16x16x32_bf16 v[116:119], a[152:155], a[116:119], v[116:119]
    ds_read_b128 a[228:231], v42 offset:2752
    v_mfma_f32_16x16x32_bf16 v[120:123], a[120:123], a[156:159], v[120:123]
    buffer_load_dwordx4 v[196:199], v28, s[8:11], s28 offen offset:1024 sc1
    v_mfma_f32_16x16x32_bf16 v[120:123], a[152:155], a[124:127], v[120:123]
    ds_read_b128 a[232:235], v41 offset:704
    v_mfma_f32_16x16x32_bf16 v[124:127], a[128:131], a[156:159], v[124:127]
    ds_read_b64_tr_b16 a[66:67], v46 offset:50176
    v_mfma_f32_16x16x32_bf16 v[124:127], a[152:155], a[132:135], v[124:127]
    ds_read_b128 a[236:239], v42 offset:3264
    s_waitcnt lgkmcnt(15)
    v_mfma_f32_16x16x32_bf16 v[120:123], a[112:115], a[164:167], v[120:123]
    buffer_load_dwordx4 v[200:203], v29, s[8:11], s28 offen offset:0 sc1
    v_mfma_f32_16x16x32_bf16 v[120:123], a[160:163], a[116:119], v[120:123]
    ds_read_b128 a[240:243], v41 offset:192
    v_mfma_f32_16x16x32_bf16 v[124:127], a[120:123], a[164:167], v[124:127]
    ds_read_b64_tr_b16 a[68:69], v47 offset:49152
    v_mfma_f32_16x16x32_bf16 v[124:127], a[160:163], a[124:127], v[124:127]
    ds_read_b128 a[244:247], v42 offset:3776
    v_mfma_f32_16x16x32_bf16 v[124:127], a[112:115], a[172:175], v[124:127]
    buffer_load_dwordx4 v[204:207], v29, s[8:11], s28 offen offset:1024 sc1
    v_mfma_f32_16x16x32_bf16 v[124:127], a[168:171], a[116:119], v[124:127]
    ds_read_b64_tr_b16 a[70:71], v47 offset:50176
    s_waitcnt lgkmcnt(15)
    v_mfma_f32_16x16x32_bf16 v[96:99], a[176:179], a[180:183], v[96:99]
    ds_read_b64_tr_b16 a[72:73], v46 offset:57344
    v_mfma_f32_16x16x32_bf16 v[100:103], a[176:179], a[188:191], v[100:103]
    ds_read_b64_tr_b16 a[74:75], v46 offset:58368
    v_mfma_f32_16x16x32_bf16 v[100:103], a[184:187], a[180:183], v[100:103]
    buffer_load_dwordx4 v[208:211], v30, s[8:11], s28 offen offset:0 sc1
    v_mfma_f32_16x16x32_bf16 v[104:107], a[184:187], a[188:191], v[104:107]
    ds_read_b64_tr_b16 a[76:77], v47 offset:57344
    s_waitcnt lgkmcnt(15)
    v_mfma_f32_16x16x32_bf16 v[104:107], a[176:179], a[196:199], v[104:107]
    ds_read_b64_tr_b16 a[78:79], v47 offset:58368
    v_mfma_f32_16x16x32_bf16 v[104:107], a[192:195], a[180:183], v[104:107]
    ds_read_b64_tr_b16 a[80:81], v46 offset:0
    v_mfma_f32_16x16x32_bf16 v[108:111], a[184:187], a[196:199], v[108:111]
    buffer_load_dwordx4 v[212:215], v30, s[8:11], s28 offen offset:1024 sc1
    v_mfma_f32_16x16x32_bf16 v[108:111], a[192:195], a[188:191], v[108:111]
    ds_read_b64_tr_b16 a[82:83], v46 offset:1024
    v_mfma_f32_16x16x32_bf16 v[112:115], a[192:195], a[196:199], v[112:115]
    ds_read_b64_tr_b16 a[84:85], v47 offset:0
    v_mfma_f32_16x16x32_bf16 v[108:111], a[176:179], a[204:207], v[108:111]
    ds_read_b64_tr_b16 a[86:87], v47 offset:1024
    v_mfma_f32_16x16x32_bf16 v[108:111], a[200:203], a[180:183], v[108:111]
    s_cmp_lg_u32 s75, 0
    s_cbranch_scc1 L_slow_h2_30
L_back_h2_31:
    buffer_load_dwordx4 v[216:219], v31, s[8:11], s28 offen offset:0 sc1
    v_mfma_f32_16x16x32_bf16 v[112:115], a[184:187], a[204:207], v[112:115]
    ds_read_b64_tr_b16 a[56:57], v38 offset:53248
    v_mfma_f32_16x16x32_bf16 v[112:115], a[200:203], a[188:191], v[112:115]
    ds_read_b64_tr_b16 a[58:59], v38 offset:54272
    v_mfma_f32_16x16x32_bf16 v[116:119], a[192:195], a[204:207], v[116:119]
    ds_read_b64_tr_b16 a[88:89], v46 offset:8192
    v_mfma_f32_16x16x32_bf16 v[116:119], a[200:203], a[196:199], v[116:119]
    buffer_load_dwordx4 v[220:223], v31, s[8:11], s28 offen offset:1024 sc1
    v_mfma_f32_16x16x32_bf16 v[120:123], a[200:203], a[204:207], v[120:123]
    ds_read_b64_tr_b16 a[90:91], v46 offset:9216
    s_waitcnt lgkmcnt(15)
    v_mfma_f32_16x16x32_bf16 v[112:115], a[176:179], a[212:215], v[112:115]
    ds_read_b64_tr_b16 a[92:93], v47 offset:8192
    v_mfma_f32_16x16x32_bf16 v[112:115], a[208:211], a[180:183], v[112:115]
    ds_read_b64_tr_b16 a[94:95], v47 offset:9216
    v_mfma_f32_16x16x32_bf16 v[116:119], a[184:187], a[212:215], v[116:119]
    buffer_load_dwordx4 v[224:227], v12, s[8:11], s28 offen offset:0 sc1
    v_mfma_f32_16x16x32_bf16 v[116:119], a[208:211], a[188:191], v[116:119]
    ds_read_b64_tr_b16 a[60:61], v39 offset:53248
    v_mfma_f32_16x16x32_bf16 v[120:123], a[192:195], a[212:215], v[120:123]
    ds_read_b64_tr_b16 a[62:63], v39 offset:54272
    v_mfma_f32_16x16x32_bf16 v[120:123], a[208:211], a[196:199], v[120:123]
    ds_read_b64_tr_b16 a[96:97], v46 offset:16384
    v_mfma_f32_16x16x32_bf16 v[124:127], a[200:203], a[212:215], v[124:127]
    buffer_load_dwordx4 v[228:231], v12, s[8:11], s28 offen offset:1024 sc1
    v_mfma_f32_16x16x32_bf16 v[124:127], a[208:211], a[204:207], v[124:127]
    ds_read_b64_tr_b16 a[98:99], v46 offset:17408
    v_mfma_f32_16x16x32_bf16 v[116:119], a[176:179], a[228:231], v[116:119]
    ds_read_b64_tr_b16 a[100:101], v47 offset:16384
    v_mfma_f32_16x16x32_bf16 v[116:119], a[224:227], a[180:183], v[116:119]
    ds_read_b64_tr_b16 a[102:103], v47 offset:17408
    v_mfma_f32_16x16x32_bf16 v[120:123], a[184:187], a[228:231], v[120:123]
    buffer_load_dwordx4 v[232:235], v13, s[8:11], s28 offen offset:0 sc1
    v_mfma_f32_16x16x32_bf16 v[120:123], a[224:227], a[188:191], v[120:123]
    v_mfma_f32_16x16x32_bf16 v[124:127], a[192:195], a[228:231], v[124:127]
    v_mfma_f32_16x16x32_bf16 v[124:127], a[224:227], a[196:199], v[124:127]
    s_waitcnt vmcnt(11)
    ds_read_b64_tr_b16 a[104:105], v46 offset:24576
    v_mfma_f32_16x16x32_bf16 v[120:123], a[176:179], a[236:239], v[120:123]
    buffer_load_dwordx4 v[236:239], v13, s[8:11], s28 offen offset:1024 sc1
    v_mfma_f32_16x16x32_bf16 v[120:123], a[232:235], a[180:183], v[120:123]
    ds_read_b64_tr_b16 a[106:107], v46 offset:25600
    v_mfma_f32_16x16x32_bf16 v[124:127], a[184:187], a[236:239], v[124:127]
    ds_read_b64_tr_b16 a[108:109], v47 offset:24576
    v_mfma_f32_16x16x32_bf16 v[124:127], a[232:235], a[188:191], v[124:127]
    ds_read_b64_tr_b16 a[110:111], v47 offset:25600
    s_waitcnt lgkmcnt(15)
    v_mfma_f32_16x16x32_bf16 v[124:127], a[176:179], a[244:247], v[124:127]
    s_cmp_lg_u32 s75, 0
    s_cbranch_scc1 L_slow_h2_34
L_back_h2_35:
    buffer_load_dwordx4 v[240:243], v28, s[8:11], s29 offen offset:0 sc1
    v_mfma_f32_16x16x32_bf16 v[124:127], a[240:243], a[180:183], v[124:127]
    s_cmp_lg_u32 s75, 0
    s_cbranch_scc1 L_slow_h_38
L_back_h_39:
    v_mfma_f32_32x32x16_bf16 v[144:159], a[4:7], v[60:63], 0
    v_mfma_f32_32x32x16_bf16 v[128:143], a[0:3], v[60:63], 0
    buffer_load_dwordx4 v[244:247], v28, s[8:11], s29 offen offset:1024 sc1
    v_mfma_f32_32x32x16_bf16 v[144:159], a[12:15], v[64:67], v[144:159]
    ds_write2_b64 v21, v[96:97], v[98:99] offset0:0 offset1:16
    v_mfma_f32_32x32x16_bf16 v[128:143], a[8:11], v[64:67], v[128:143]
    buffer_load_dwordx4 v[248:251], v29, s[8:11], s29 offen offset:0 sc1
    ds_write2_b64 v21, v[100:101], v[102:103] offset0:128 offset1:144
    s_waitcnt vmcnt(14)
    v_mfma_f32_32x32x16_bf16 v[144:159], a[20:23], v[192:195], v[144:159]
    v_add_u32 v21, 0x800, v21
    ds_write2_b64 v21, v[104:105], v[106:107] offset0:0 offset1:16
    v_mfma_f32_32x32x16_bf16 v[128:143], a[16:19], v[192:195], v[128:143]
    buffer_load_dwordx4 v[252:255], v29, s[8:11], s29 offen offset:1024 sc1
    ds_write2_b64 v21, v[108:109], v[110:111] offset0:128 offset1:144
    s_waitcnt vmcnt(14)
    v_mfma_f32_32x32x16_bf16 v[144:159], a[28:31], v[196:199], v[144:159]
    v_add_u32 v21, 0x800, v21
    ds_write2_b64 v21, v[112:113], v[114:115] offset0:0 offset1:16
    v_mfma_f32_32x32x16_bf16 v[128:143], a[24:27], v[196:199], v[128:143]
    buffer_load_dwordx4 a[248:251], v30, s[8:11], s29 offen offset:0 sc1
    ds_write2_b64 v21, v[116:117], v[118:119] offset0:128 offset1:144
    s_waitcnt vmcnt(14)
    v_mfma_f32_32x32x16_bf16 v[144:159], a[36:39], v[200:203], v[144:159]
    v_add_u32 v21, 0x800, v21
    ds_write2_b64 v21, v[120:121], v[122:123] offset0:0 offset1:16
    v_mfma_f32_32x32x16_bf16 v[128:143], a[32:35], v[200:203], v[128:143]
    s_add_u32 s66, s27, 0x20000
    s_mov_b64 exec, 0x7f
    buffer_load_dword v8, v5, s[20:23], s66 offen sc1
    s_mov_b64 exec, -1
    buffer_load_dwordx4 a[252:255], v30, s[8:11], s29 offen offset:1024 sc1
    s_waitcnt vmcnt(15)
    v_mfma_f32_32x32x16_bf16 v[144:159], a[44:47], v[204:207], v[144:159]
    ds_write2_b64 v21, v[124:125], v[126:127] offset0:128 offset1:144
    v_mfma_f32_32x32x16_bf16 v[128:143], a[40:43], v[204:207], v[128:143]
    buffer_load_dwordx4 a[112:115], v31, s[8:11], s29 offen offset:0 sc1
    s_waitcnt vmcnt(15)
    v_mfma_f32_32x32x16_bf16 v[144:159], a[52:55], v[208:211], v[144:159]
    v_mfma_f32_32x32x16_bf16 v[128:143], a[48:51], v[208:211], v[128:143]
    buffer_load_dwordx4 a[116:119], v31, s[8:11], s29 offen offset:1024 sc1
    s_waitcnt vmcnt(15)
    s_waitcnt lgkmcnt(15)
    v_mfma_f32_32x32x16_bf16 v[144:159], a[60:63], v[212:215], v[144:159]
    v_mfma_f32_32x32x16_bf16 v[128:143], a[56:59], v[212:215], v[128:143]
    buffer_load_dwordx4 a[120:123], v12, s[8:11], s29 offen offset:0 sc1
    s_waitcnt lgkmcnt(0)
    s_barrier
    s_waitcnt vmcnt(15)
    v_mfma_f32_32x32x16_bf16 v[144:159], a[68:71], v[216:219], v[144:159]
    ds_read_b128 v[96:99], v22 offset:0
    ds_read_b128 v[100:103], v22 offset:16
    ds_read_b128 v[104:107], v22 offset:8192
    ds_read_b128 v[108:111], v22 offset:8208
    ds_read_b128 v[112:115], v22 offset:16384
    v_mfma_f32_32x32x16_bf16 v[128:143], a[64:67], v[216:219], v[128:143]
    buffer_load_dwordx4 a[124:127], v12, s[8:11], s29 offen offset:1024 sc1
    ds_read_b128 v[116:119], v22 offset:16400
    ds_read_b128 v[120:123], v22 offset:24576
    s_waitcnt vmcnt(15)
    v_mfma_f32_32x32x16_bf16 v[144:159], a[76:79], v[220:223], v[144:159]
    ds_read_b128 v[124:127], v22 offset:24592
    v_mfma_f32_32x32x16_bf16 v[128:143], a[72:75], v[220:223], v[128:143]
    buffer_load_dwordx4 a[128:131], v13, s[8:11], s29 offen offset:0 sc1
    s_waitcnt vmcnt(15)
    v_mfma_f32_32x32x16_bf16 v[144:159], a[84:87], v[224:227], v[144:159]
    s_waitcnt lgkmcnt(4)
    v_add_f32 v96, v96, v104
    v_add_f32 v97, v97, v105
    v_add_f32 v98, v98, v106
    v_add_f32 v99, v99, v107
    v_mfma_f32_32x32x16_bf16 v[128:143], a[80:83], v[224:227], v[128:143]
    buffer_load_dwordx4 a[132:135], v13, s[8:11], s29 offen offset:1024 sc1
    v_add_f32 v100, v100, v108
    v_add_f32 v101, v101, v109
    s_waitcnt vmcnt(15)
    v_mfma_f32_32x32x16_bf16 v[144:159], a[92:95], v[228:231], v[144:159]
    v_add_f32 v102, v102, v110
    v_add_f32 v103, v103, v111
    v_cvt_pk_bf16_f32 v48, v96, v97
    v_cvt_pk_bf16_f32 v49, v98, v99
    v_cvt_pk_bf16_f32 v50, v100, v101
    v_mfma_f32_32x32x16_bf16 v[128:143], a[88:91], v[228:231], v[128:143]
    s_waitcnt vmcnt(7)
    v_cmp_ne_u32 vcc, s48, v8
    s_cbranch_vccnz L_slow_hb_42
L_back_hb_43:
    buffer_load_dwordx4 a[136:139], v28, s[8:11], s30 offen offset:0 sc1
    v_mfma_f32_32x32x16_bf16 v[144:159], a[100:103], v[232:235], v[144:159]
    v_cvt_pk_bf16_f32 v56, v102, v103
    s_waitcnt lgkmcnt(0)
    v_add_f32 v112, v112, v120
    v_add_f32 v113, v113, v121
    v_add_f32 v114, v114, v122
    v_mfma_f32_32x32x16_bf16 v[128:143], a[96:99], v[232:235], v[128:143]
    buffer_load_dwordx4 a[140:143], v28, s[8:11], s30 offen offset:1024 sc1
    v_add_f32 v115, v115, v123
    v_add_f32 v116, v116, v124
    v_mfma_f32_32x32x16_bf16 v[144:159], a[108:111], v[236:239], v[144:159]
    v_add_f32 v117, v117, v125
    v_add_f32 v118, v118, v126
    v_add_f32 v119, v119, v127
    v_cvt_pk_bf16_f32 v52, v112, v113
    v_cvt_pk_bf16_f32 v53, v114, v115
    v_mfma_f32_32x32x16_bf16 v[128:143], a[104:107], v[236:239], v[128:143]
    buffer_load_dwordx4 a[144:147], v29, s[8:11], s30 offen offset:0 sc1
    v_cvt_pk_bf16_f32 v54, v116, v117
    v_cvt_pk_bf16_f32 v57, v118, v119
    v_mfma_f32_32x32x16_bf16 v[176:191], a[4:7], v[68:71], 0
    buffer_store_dwordx4 v[48:51], v23, s[20:23], s40 offen offset:0 sc1
    buffer_store_dwordx4 v[52:55], v23, s[20:23], s40 offen offset:128 sc1
    buffer_store_dwordx4 v[56:59], v23, s[20:23], s40 offen offset:256 sc1
    v_mfma_f32_32x32x16_bf16 v[160:175], a[0:3], v[68:71], 0
    buffer_load_dwordx4 a[148:151], v29, s[8:11], s30 offen offset:1024 sc1
    s_nop 2
    ds_write_b128 v33, v[128:131] offset:0
    v_mfma_f32_32x32x16_bf16 v[176:191], a[12:15], v[72:75], v[176:191]
    ds_write_b128 v33, v[132:135] offset:1024
    v_mfma_f32_32x32x16_bf16 v[160:175], a[8:11], v[72:75], v[160:175]
    buffer_load_dwordx4 a[152:155], v30, s[8:11], s30 offen offset:0 sc1
    ds_write_b128 v33, v[136:139] offset:2048
    v_mfma_f32_32x32x16_bf16 v[176:191], a[20:23], v[240:243], v[176:191]
    ds_write_b128 v33, v[140:143] offset:3072
    v_accvgpr_read_b32 v97, a216
    v_lshlrev_b32 v96, 16, v97
    v_and_b32 v97, s49, v97
    v_mfma_f32_32x32x16_bf16 v[160:175], a[16:19], v[240:243], v[160:175]
    buffer_load_dwordx4 a[156:159], v30, s[8:11], s30 offen offset:1024 sc1
    ds_write_b128 v34, v[144:147] offset:0
    v_mfma_f32_32x32x16_bf16 v[176:191], a[28:31], v[244:247], v[176:191]
    ds_write_b128 v34, v[148:151] offset:1024
    v_accvgpr_read_b32 v99, a217
    v_lshlrev_b32 v98, 16, v99
    v_and_b32 v99, s49, v99
    v_mfma_f32_32x32x16_bf16 v[160:175], a[24:27], v[244:247], v[160:175]
    buffer_load_dwordx4 a[160:163], v31, s[8:11], s30 offen offset:0 sc1
    ds_write_b128 v34, v[152:155] offset:2048
    v_mfma_f32_32x32x16_bf16 v[176:191], a[36:39], v[248:251], v[176:191]
    ds_write_b128 v34, v[156:159] offset:3072
    v_accvgpr_read_b32 v101, a218
    v_lshlrev_b32 v100, 16, v101
    v_and_b32 v101, s49, v101
    v_mfma_f32_32x32x16_bf16 v[160:175], a[32:35], v[248:251], v[160:175]
    buffer_load_dwordx4 a[164:167], v31, s[8:11], s30 offen offset:1024 sc1
    v_accvgpr_read_b32 v103, a219
    v_lshlrev_b32 v102, 16, v103
    v_mfma_f32_32x32x16_bf16 v[176:191], a[44:47], v[252:255], v[176:191]
    v_and_b32 v103, s49, v103
    v_accvgpr_read_b32 v105, a220
    v_lshlrev_b32 v104, 16, v105
    v_and_b32 v105, s49, v105
    v_accvgpr_read_b32 v107, a221
    v_mfma_f32_32x32x16_bf16 v[160:175], a[40:43], v[252:255], v[160:175]
    buffer_load_dwordx4 a[168:171], v12, s[8:11], s30 offen offset:0 sc1
    v_lshlrev_b32 v106, 16, v107
    v_and_b32 v107, s49, v107
    v_mfma_f32_32x32x16_bf16 v[176:191], a[52:55], a[248:251], v[176:191]
    v_accvgpr_read_b32 v109, a222
    v_lshlrev_b32 v108, 16, v109
    v_and_b32 v109, s49, v109
    v_accvgpr_read_b32 v111, a223
    v_lshlrev_b32 v110, 16, v111
    v_mfma_f32_32x32x16_bf16 v[160:175], a[48:51], a[248:251], v[160:175]
    buffer_load_dwordx4 a[172:175], v12, s[8:11], s30 offen offset:1024 sc1
    s_waitcnt lgkmcnt(0)
    s_barrier
    s_waitcnt vmcnt(19)
    v_mfma_f32_32x32x16_bf16 v[176:191], a[60:63], a[252:255], v[176:191]
    ds_read_b128 v[128:131], v35 offset:4096
    ds_read_b128 v[132:135], v35 offset:5120
    ds_read_b128 v[136:139], v35 offset:6144
    ds_read_b128 v[140:143], v35 offset:7168
    ds_read_b128 v[144:147], v35 offset:8192
    v_mfma_f32_32x32x16_bf16 v[160:175], a[56:59], a[252:255], v[160:175]
    buffer_load_dwordx4 a[176:179], v13, s[8:11], s30 offen offset:0 sc1
    ds_read_b128 v[148:151], v35 offset:9216
    ds_read_b128 v[152:155], v35 offset:10240
    s_waitcnt vmcnt(19)
    v_mfma_f32_32x32x16_bf16 v[176:191], a[68:71], a[112:115], v[176:191]
    ds_read_b128 v[156:159], v35 offset:11264
    v_and_b32 v111, s49, v111
    v_mul_f32 v17, v45, v45
    v_mul_f32 v44, v44, v45
    v_fma_f32 v60, v96, v45, -v44
    v_mfma_f32_32x32x16_bf16 v[160:175], a[64:67], a[112:115], v[160:175]
    buffer_load_dwordx4 a[180:183], v13, s[8:11], s30 offen offset:1024 sc1
    v_fma_f32 v61, v97, v45, -v44
    v_fma_f32 v62, v98, v45, -v44
    s_waitcnt vmcnt(19)
    v_mfma_f32_32x32x16_bf16 v[176:191], a[76:79], a[116:119], v[176:191]
    s_waitcnt lgkmcnt(0)
    v_add_f32 v128, v128, v144
    v_add_f32 v129, v129, v145
    v_add_f32 v130, v130, v146
    v_add_f32 v131, v131, v147
    v_mfma_f32_32x32x16_bf16 v[160:175], a[72:75], a[116:119], v[160:175]
    buffer_load_dwordx4 a[184:187], v28, s[8:11], s31 offen offset:0 sc1
    v_add_f32 v132, v132, v148
    v_add_f32 v133, v133, v149
    s_waitcnt vmcnt(19)
    v_mfma_f32_32x32x16_bf16 v[176:191], a[84:87], a[120:123], v[176:191]
    v_add_f32 v134, v134, v150
    v_add_f32 v135, v135, v151
    v_add_f32 v136, v136, v152
    v_add_f32 v137, v137, v153
    v_add_f32 v138, v138, v154
    v_mfma_f32_32x32x16_bf16 v[160:175], a[80:83], a[120:123], v[160:175]
    buffer_load_dwordx4 a[188:191], v28, s[8:11], s31 offen offset:1024 sc1
    v_add_f32 v139, v139, v155
    v_add_f32 v140, v140, v156
    s_waitcnt vmcnt(19)
    v_mfma_f32_32x32x16_bf16 v[176:191], a[92:95], a[124:127], v[176:191]
    v_add_f32 v141, v141, v157
    v_add_f32 v142, v142, v158
    v_add_f32 v143, v143, v159
    v_fma_f32 v63, v99, v45, -v44
    v_fma_f32 v64, v100, v45, -v44
    v_mfma_f32_32x32x16_bf16 v[160:175], a[88:91], a[124:127], v[160:175]
    buffer_load_dwordx4 a[192:195], v29, s[8:11], s31 offen offset:0 sc1
    v_fma_f32 v65, v101, v45, -v44
    v_fma_f32 v66, v102, v45, -v44
    s_waitcnt vmcnt(19)
    v_mfma_f32_32x32x16_bf16 v[176:191], a[100:103], a[128:131], v[176:191]
    v_fma_f32 v67, v103, v45, -v44
    v_fma_f32 v68, v104, v45, -v44
    v_fma_f32 v69, v105, v45, -v44
    v_fma_f32 v70, v106, v45, -v44
    v_fma_f32 v71, v107, v45, -v44
    v_mfma_f32_32x32x16_bf16 v[160:175], a[96:99], a[128:131], v[160:175]
    buffer_load_dwordx4 a[196:199], v29, s[8:11], s31 offen offset:1024 sc1
    v_fma_f32 v72, v108, v45, -v44
    v_fma_f32 v73, v109, v45, -v44
    s_waitcnt vmcnt(19)
    v_mfma_f32_32x32x16_bf16 v[176:191], a[108:111], a[132:135], v[176:191]
    v_fma_f32 v74, v110, v45, -v44
    v_fma_f32 v75, v111, v45, -v44
    v_mfma_f32_32x32x16_bf16 v[160:175], a[104:107], a[132:135], v[160:175]
    buffer_load_dwordx4 a[200:203], v30, s[8:11], s31 offen offset:0 sc1
    v_mfma_f32_32x32x16_bf16 v[208:223], a[4:7], v[76:79], 0
    v_mfma_f32_32x32x16_bf16 v[192:207], a[0:3], v[76:79], 0
    buffer_load_dwordx4 a[204:207], v30, s[8:11], s31 offen offset:1024 sc1
    s_nop 4
    ds_write_b128 v32, v[176:179] offset:0
    v_mfma_f32_32x32x16_bf16 v[208:223], a[12:15], v[80:83], v[208:223]
    ds_write_b128 v32, v[180:183] offset:1024
    ds_write_b128 v32, v[184:187] offset:2048
    ds_write_b128 v32, v[188:191] offset:3072
    v_mfma_f32_32x32x16_bf16 v[192:207], a[8:11], v[80:83], v[192:207]
    buffer_load_dwordx4 a[208:211], v31, s[8:11], s31 offen offset:0 sc1
    v_add_f32 v160, v160, v128
    v_add_f32 v161, v161, v129
    s_waitcnt vmcnt(21)
    v_mfma_f32_32x32x16_bf16 v[208:223], a[20:23], a[136:139], v[208:223]
    v_add_f32 v162, v162, v130
    v_add_f32 v163, v163, v131
    v_add_f32 v164, v164, v132
    v_add_f32 v165, v165, v133
    v_add_f32 v166, v166, v134
    v_mfma_f32_32x32x16_bf16 v[192:207], a[16:19], a[136:139], v[192:207]
    buffer_load_dwordx4 a[212:215], v31, s[8:11], s31 offen offset:1024 sc1
    v_add_f32 v167, v167, v135
    v_add_f32 v168, v168, v136
    s_waitcnt vmcnt(21)
    v_mfma_f32_32x32x16_bf16 v[208:223], a[28:31], a[140:143], v[208:223]
    v_add_f32 v169, v169, v137
    v_add_f32 v170, v170, v138
    v_add_f32 v171, v171, v139
    v_add_f32 v172, v172, v140
    v_add_f32 v173, v173, v141
    v_mfma_f32_32x32x16_bf16 v[192:207], a[24:27], a[140:143], v[192:207]
    buffer_load_dwordx4 a[224:227], v12, s[8:11], s31 offen offset:0 sc1
    v_add_f32 v174, v174, v142
    v_add_f32 v175, v175, v143
    s_waitcnt vmcnt(21)
    v_mfma_f32_32x32x16_bf16 v[208:223], a[36:39], a[144:147], v[208:223]
    s_waitcnt lgkmcnt(0)
    s_barrier
    ds_read_b128 v[176:179], v35 offset:0
    ds_read_b128 v[180:183], v35 offset:1024
    ds_read_b128 v[184:187], v35 offset:2048
    v_mfma_f32_32x32x16_bf16 v[192:207], a[32:35], a[144:147], v[192:207]
    buffer_load_dwordx4 a[228:231], v12, s[8:11], s31 offen offset:1024 sc1
    ds_read_b128 v[188:191], v35 offset:3072
    v_mov_b32 v131, s48
    s_waitcnt vmcnt(18)
    v_mfma_f32_32x32x16_bf16 v[208:223], a[44:47], a[148:151], v[208:223]
    v_mov_b32 v135, s48
    v_mov_b32 v138, s48
    v_mov_b32 v139, s48
    buffer_load_dwordx4 v[112:115], v18, s[20:23], s41 offen offset:0 sc1
    buffer_load_dwordx4 v[116:119], v18, s[20:23], s41 offen offset:128 sc1
    buffer_load_dwordx4 v[120:123], v18, s[20:23], s41 offen offset:256 sc1
    v_mfma_f32_32x32x16_bf16 v[192:207], a[40:43], a[148:151], v[192:207]
    buffer_load_dwordx4 a[232:235], v13, s[8:11], s31 offen offset:0 sc1
    s_waitcnt vmcnt(21)
    v_mfma_f32_32x32x16_bf16 v[208:223], a[52:55], a[152:155], v[208:223]
    s_waitcnt lgkmcnt(0)
    v_add_f32 v160, v160, v176
    v_add_f32 v161, v161, v177
    v_cvt_pk_bf16_f32 v128, v160, v161
    v_add_f32 v162, v162, v178
    v_mfma_f32_32x32x16_bf16 v[192:207], a[48:51], a[152:155], v[192:207]
    buffer_load_dwordx4 a[236:239], v13, s[8:11], s31 offen offset:1024 sc1
    v_add_f32 v163, v163, v179
    v_cvt_pk_bf16_f32 v129, v162, v163
    s_waitcnt vmcnt(21)
    v_mfma_f32_32x32x16_bf16 v[208:223], a[60:63], a[156:159], v[208:223]
    v_add_f32 v164, v164, v180
    v_add_f32 v165, v165, v181
    v_cvt_pk_bf16_f32 v130, v164, v165
    v_add_f32 v166, v166, v182
    v_add_f32 v167, v167, v183
    v_mfma_f32_32x32x16_bf16 v[192:207], a[56:59], a[156:159], v[192:207]
    v_cvt_pk_bf16_f32 v132, v166, v167
    v_add_f32 v168, v168, v184
    v_add_f32 v169, v169, v185
    v_cvt_pk_bf16_f32 v133, v168, v169
    v_add_f32 v170, v170, v186
    s_waitcnt vmcnt(20)
    v_mfma_f32_32x32x16_bf16 v[208:223], a[68:71], a[160:163], v[208:223]
    v_add_f32 v171, v171, v187
    v_cvt_pk_bf16_f32 v134, v170, v171
    v_add_f32 v172, v172, v188
    v_add_f32 v173, v173, v189
    v_cvt_pk_bf16_f32 v136, v172, v173
    v_mfma_f32_32x32x16_bf16 v[192:207], a[64:67], a[160:163], v[192:207]
    v_add_f32 v174, v174, v190
    v_add_f32 v175, v175, v191
    v_cvt_pk_bf16_f32 v137, v174, v175
    buffer_store_dwordx4 v[128:131], v4, s[20:23], s42 offen offset:0 sc1
    buffer_store_dwordx4 v[132:135], v4, s[20:23], s42 offen offset:1024 sc1
    buffer_store_dwordx4 v[136:139], v4, s[20:23], s42 offen offset:2048 sc1
    s_xor_b32 s42, s42, 0x4000
    s_waitcnt vmcnt(22)
    v_mfma_f32_32x32x16_bf16 v[208:223], a[76:79], a[164:167], v[208:223]
    v_subrev_u32 v32, 114688, v32
    v_subrev_u32 v33, 114688, v33
    v_subrev_u32 v34, 114688, v34
    v_subrev_u32 v35, 114688, v35
    v_mfma_f32_32x32x16_bf16 v[192:207], a[72:75], a[164:167], v[192:207]
    s_waitcnt vmcnt(21)
    v_mfma_f32_32x32x16_bf16 v[208:223], a[84:87], a[168:171], v[208:223]
    v_mfma_f32_32x32x16_bf16 v[192:207], a[80:83], a[168:171], v[192:207]
    s_waitcnt vmcnt(20)
    v_mfma_f32_32x32x16_bf16 v[208:223], a[92:95], a[172:175], v[208:223]
    v_mfma_f32_32x32x16_bf16 v[192:207], a[88:91], a[172:175], v[192:207]
    s_waitcnt vmcnt(19)
    v_mfma_f32_32x32x16_bf16 v[208:223], a[100:103], a[176:179], v[208:223]
    v_mfma_f32_32x32x16_bf16 v[192:207], a[96:99], a[176:179], v[192:207]
    s_waitcnt vmcnt(18)
    v_mfma_f32_32x32x16_bf16 v[208:223], a[108:111], a[180:183], v[208:223]
    v_mfma_f32_32x32x16_bf16 v[192:207], a[104:107], a[180:183], v[192:207]
    v_mfma_f32_32x32x16_bf16 v[240:255], a[4:7], v[84:87], 0
    v_mfma_f32_32x32x16_bf16 v[224:239], a[0:3], v[84:87], 0
    s_nop 9
    ds_write_b128 v33, v[192:195] offset:0
    v_mfma_f32_32x32x16_bf16 v[240:255], a[12:15], v[88:91], v[240:255]
    ds_write_b128 v33, v[196:199] offset:1024
    v_mfma_f32_32x32x16_bf16 v[224:239], a[8:11], v[88:91], v[224:239]
    ds_write_b128 v33, v[200:203] offset:2048
    s_waitcnt vmcnt(17)
    v_mfma_f32_32x32x16_bf16 v[240:255], a[20:23], a[184:187], v[240:255]
    ds_write_b128 v33, v[204:207] offset:3072
    v_mfma_f32_32x32x16_bf16 v[224:239], a[16:19], a[184:187], v[224:239]
    ds_write_b128 v34, v[208:211] offset:0
    s_waitcnt vmcnt(16)
    v_mfma_f32_32x32x16_bf16 v[240:255], a[28:31], a[188:191], v[240:255]
    ds_write_b128 v34, v[212:215] offset:1024
    v_mfma_f32_32x32x16_bf16 v[224:239], a[24:27], a[188:191], v[224:239]
    ds_write_b128 v34, v[216:219] offset:2048
    s_waitcnt vmcnt(15)
    v_mfma_f32_32x32x16_bf16 v[240:255], a[36:39], a[192:195], v[240:255]
    ds_write_b128 v34, v[220:223] offset:3072
    v_mfma_f32_32x32x16_bf16 v[224:239], a[32:35], a[192:195], v[224:239]
    s_waitcnt vmcnt(5)
    s_mov_b32 s63, 0x40000
L_il_y_46:
    v_xor_b32 v124, s48, v115
    v_bitop3_b32 v124, v119, s48, v124 bitop3:0xbe
    v_bitop3_b32 v124, v123, s48, v124 bitop3:0xbe
    v_cmp_ne_u32 vcc, 0, v124
    s_cbranch_vccz L_ilok_y_47
    buffer_load_dwordx4 v[112:115], v18, s[20:23], s41 offen offset:0 sc1
    buffer_load_dwordx4 v[116:119], v18, s[20:23], s41 offen offset:128 sc1
    buffer_load_dwordx4 v[120:123], v18, s[20:23], s41 offen offset:256 sc1
    s_sub_u32 s63, s63, 1
    s_waitcnt vmcnt(0)
    s_cbranch_scc0 L_il_y_46
L_ilok_y_47:
    v_mfma_f32_32x32x16_bf16 v[240:255], a[44:47], a[196:199], v[240:255]
    v_mov_b32 v115, v120
    v_mov_b32 v119, v121
    ds_write_b128 v19, v[112:115]
    ds_write_b128 v19, v[116:119] offset:128
    v_mfma_f32_32x32x16_bf16 v[224:239], a[40:43], a[196:199], v[224:239]
    v_mfma_f32_32x32x16_bf16 v[240:255], a[52:55], a[200:203], v[240:255]
    v_mfma_f32_32x32x16_bf16 v[224:239], a[48:51], a[200:203], v[224:239]
    v_mfma_f32_32x32x16_bf16 v[240:255], a[60:63], a[204:207], v[240:255]
    buffer_load_dwordx4 v[144:147], v4, s[20:23], s42 offen offset:0 sc1
    buffer_load_dwordx4 v[148:151], v4, s[20:23], s42 offen offset:1024 sc1
    buffer_load_dwordx4 v[152:155], v4, s[20:23], s42 offen offset:2048 sc1
    v_mfma_f32_32x32x16_bf16 v[224:239], a[56:59], a[204:207], v[224:239]
    s_waitcnt lgkmcnt(0)
    s_barrier
    ds_read_b128 v[192:195], v35 offset:4096
    ds_read_b128 v[196:199], v35 offset:5120
    ds_read_b128 v[200:203], v35 offset:6144
    v_mfma_f32_32x32x16_bf16 v[240:255], a[68:71], a[208:211], v[240:255]
    ds_read_b128 v[204:207], v35 offset:7168
    ds_read_b128 v[208:211], v35 offset:8192
    ds_read_b128 v[212:215], v35 offset:9216
    ds_read_b128 v[216:219], v35 offset:10240
    ds_read_b128 v[220:223], v35 offset:11264
    v_mfma_f32_32x32x16_bf16 v[224:239], a[64:67], a[208:211], v[224:239]
    ds_read_b64_tr_b16 v[76:77], v20 offset:0
    ds_read_b64_tr_b16 v[78:79], v20 offset:1024
    ds_read_b64_tr_b16 v[80:81], v20 offset:2048
    ds_read_b64_tr_b16 v[82:83], v20 offset:3072
    v_mfma_f32_32x32x16_bf16 v[240:255], a[76:79], a[212:215], v[240:255]
    v_mfma_f32_32x32x16_bf16 v[224:239], a[72:75], a[212:215], v[224:239]
    s_waitcnt lgkmcnt(4)
    v_add_f32 v192, v192, v208
    v_add_f32 v193, v193, v209
    v_add_f32 v194, v194, v210
    v_add_f32 v195, v195, v211
    v_mfma_f32_32x32x16_bf16 v[240:255], a[84:87], a[224:227], v[240:255]
    v_add_f32 v196, v196, v212
    v_add_f32 v197, v197, v213
    v_add_f32 v198, v198, v214
    v_add_f32 v199, v199, v215
    v_add_f32 v200, v200, v216
    v_mfma_f32_32x32x16_bf16 v[224:239], a[80:83], a[224:227], v[224:239]
    v_add_f32 v201, v201, v217
    v_add_f32 v202, v202, v218
    v_add_f32 v203, v203, v219
    v_add_f32 v204, v204, v220
    v_add_f32 v205, v205, v221
    v_mfma_f32_32x32x16_bf16 v[240:255], a[92:95], a[228:231], v[240:255]
    v_add_f32 v206, v206, v222
    v_add_f32 v207, v207, v223
    s_waitcnt lgkmcnt(0)
    v_lshlrev_b32 v84, 16, v76
    v_and_b32 v85, s49, v76
    v_mfma_f32_32x32x16_bf16 v[224:239], a[88:91], a[228:231], v[224:239]
    v_fmac_f32 v96, v60, v84
    v_fmac_f32 v97, v61, v85
    v_lshlrev_b32 v86, 16, v77
    v_and_b32 v87, s49, v77
    v_fmac_f32 v98, v62, v86
    s_waitcnt vmcnt(7)
    v_mfma_f32_32x32x16_bf16 v[240:255], a[100:103], a[232:235], v[240:255]
    v_fmac_f32 v99, v63, v87
    v_lshlrev_b32 v84, 16, v78
    v_and_b32 v85, s49, v78
    v_fmac_f32 v100, v64, v84
    v_fmac_f32 v101, v65, v85
    v_mfma_f32_32x32x16_bf16 v[224:239], a[96:99], a[232:235], v[224:239]
    v_lshlrev_b32 v86, 16, v79
    v_and_b32 v87, s49, v79
    v_fmac_f32 v102, v66, v86
    v_fmac_f32 v103, v67, v87
    v_lshlrev_b32 v84, 16, v80
    s_waitcnt vmcnt(6)
    v_mfma_f32_32x32x16_bf16 v[240:255], a[108:111], a[236:239], v[240:255]
    v_and_b32 v85, s49, v80
    v_fmac_f32 v104, v68, v84
    v_fmac_f32 v105, v69, v85
    v_lshlrev_b32 v86, 16, v81
    v_and_b32 v87, s49, v81
    v_mfma_f32_32x32x16_bf16 v[224:239], a[104:107], a[236:239], v[224:239]
    v_fmac_f32 v106, v70, v86
    v_fmac_f32 v107, v71, v87
    v_lshlrev_b32 v84, 16, v82
    v_and_b32 v85, s49, v82
    v_fmac_f32 v108, v72, v84
    v_fmac_f32 v109, v73, v85
    v_lshlrev_b32 v86, 16, v83
    v_and_b32 v87, s49, v83
    v_fmac_f32 v110, v74, v86
    v_fmac_f32 v111, v75, v87
    s_nop 5
    ds_write_b128 v32, v[240:243] offset:0
    ds_write_b128 v32, v[244:247] offset:1024
    ds_write_b128 v32, v[248:251] offset:2048
    ds_write_b128 v32, v[252:255] offset:3072
    v_pk_add_f32 v[224:225], v[224:225], v[192:193]
    v_pk_add_f32 v[226:227], v[226:227], v[194:195]
    v_pk_add_f32 v[228:229], v[228:229], v[196:197]
    v_pk_add_f32 v[230:231], v[230:231], v[198:199]
    v_pk_add_f32 v[232:233], v[232:233], v[200:201]
    v_pk_add_f32 v[234:235], v[234:235], v[202:203]
    v_pk_add_f32 v[236:237], v[236:237], v[204:205]
    v_pk_add_f32 v[238:239], v[238:239], v[206:207]
    s_waitcnt lgkmcnt(0)
    s_barrier
    ds_read_b128 v[240:243], v35 offset:0
    ds_read_b128 v[244:247], v35 offset:1024
    ds_read_b128 v[248:251], v35 offset:2048
    ds_read_b128 v[252:255], v35 offset:3072
    s_waitcnt vmcnt(0)
    s_mov_b32 s63, 0x40000
L_il_xr_48:
    v_xor_b32 v156, s48, v147
    v_bitop3_b32 v156, v151, s48, v156 bitop3:0xbe
    v_bitop3_b32 v156, v155, s48, v156 bitop3:0xbe
    v_cmp_ne_u32 vcc, 0, v156
    s_cbranch_vccz L_ilok_xr_49
    buffer_load_dwordx4 v[144:147], v4, s[20:23], s42 offen offset:0 sc1
    buffer_load_dwordx4 v[148:151], v4, s[20:23], s42 offen offset:1024 sc1
    buffer_load_dwordx4 v[152:155], v4, s[20:23], s42 offen offset:2048 sc1
    s_sub_u32 s63, s63, 1
    s_waitcnt vmcnt(0)
    s_cbranch_scc0 L_il_xr_48
L_ilok_xr_49:
    v_lshlrev_b32 v160, 16, v144
    v_and_b32 v161, s49, v144
    v_lshlrev_b32 v162, 16, v145
    v_and_b32 v163, s49, v145
    v_lshlrev_b32 v164, 16, v146
    v_and_b32 v165, s49, v146
    v_lshlrev_b32 v166, 16, v148
    v_and_b32 v167, s49, v148
    v_lshlrev_b32 v168, 16, v149
    v_and_b32 v169, s49, v149
    v_lshlrev_b32 v170, 16, v150
    v_and_b32 v171, s49, v150
    v_lshlrev_b32 v172, 16, v152
    v_and_b32 v173, s49, v152
    v_lshlrev_b32 v174, 16, v153
    v_and_b32 v175, s49, v153
    v_pk_add_f32 v[224:225], v[224:225], v[160:161]
    v_pk_add_f32 v[226:227], v[226:227], v[162:163]
    v_pk_add_f32 v[228:229], v[228:229], v[164:165]
    v_pk_add_f32 v[230:231], v[230:231], v[166:167]
    v_pk_add_f32 v[232:233], v[232:233], v[168:169]
    v_pk_add_f32 v[234:235], v[234:235], v[170:171]
    v_pk_add_f32 v[236:237], v[236:237], v[172:173]
    v_pk_add_f32 v[238:239], v[238:239], v[174:175]
    s_waitcnt lgkmcnt(0)
    v_pk_add_f32 v[224:225], v[224:225], v[240:241]
    v_pk_add_f32 v[226:227], v[226:227], v[242:243]
    v_pk_add_f32 v[228:229], v[228:229], v[244:245]
    v_pk_add_f32 v[230:231], v[230:231], v[246:247]
    v_pk_add_f32 v[232:233], v[232:233], v[248:249]
    v_pk_add_f32 v[234:235], v[234:235], v[250:251]
    v_pk_add_f32 v[236:237], v[236:237], v[252:253]
    v_pk_add_f32 v[238:239], v[238:239], v[254:255]
    v_mov_b32 v160, v17
    v_mov_b32 v161, v17
    v_pk_fma_f32 v[96:97], v[224:225], v[160:161], v[96:97]
    v_pk_fma_f32 v[98:99], v[226:227], v[160:161], v[98:99]
    v_pk_fma_f32 v[100:101], v[228:229], v[160:161], v[100:101]
    v_pk_fma_f32 v[102:103], v[230:231], v[160:161], v[102:103]
    v_pk_fma_f32 v[104:105], v[232:233], v[160:161], v[104:105]
    v_pk_fma_f32 v[106:107], v[234:235], v[160:161], v[106:107]
    v_pk_fma_f32 v[108:109], v[236:237], v[160:161], v[108:109]
    v_pk_fma_f32 v[110:111], v[238:239], v[160:161], v[110:111]
    v_cvt_pk_bf16_f32 v112, v96, v97
    v_cvt_pk_bf16_f32 v113, v98, v99
    v_cvt_pk_bf16_f32 v114, v100, v101
    v_cvt_pk_bf16_f32 v115, v102, v103
    v_cvt_pk_bf16_f32 v116, v104, v105
    v_cvt_pk_bf16_f32 v117, v106, v107
    v_cvt_pk_bf16_f32 v118, v108, v109
    v_cvt_pk_bf16_f32 v119, v110, v111
    s_nop 1
    v_permlane32_swap_b32 v112, v114
    v_permlane32_swap_b32 v113, v115
    v_permlane32_swap_b32 v116, v118
    v_permlane32_swap_b32 v117, v119
    s_add_u32 s50, s43, 16384
    s_nop 0
    v_permlane16_swap_b32 v112, v116
    v_permlane16_swap_b32 v113, v117
    v_permlane16_swap_b32 v114, v118
    v_permlane16_swap_b32 v115, v119
    buffer_store_dwordx4 v[112:115], v16, s[36:39], s43 offen sc1
    buffer_store_dwordx4 v[116:119], v16, s[36:39], s50 offen sc1
    s_endpgm
L_aux:
    s_lshr_b32 s46, s44, 1
    s_lshl_b32 s46, s46, 2
    s_and_b32 s50, s45, 3
    s_add_u32 s46, s46, s50
    s_lshl_b32 s54, s3, 12
    v_lshlrev_b32 v4, 4, v1
    s_mov_b32 s49, 0xffff0000
    s_lshl_b32 s61, s44, 5
    s_add_u32 s61, s61, s45
    s_lshl_b32 s56, s3, 11
    s_mov_b32 s72, s62
    s_sub_u32 s68, s45, 28
    s_lshl_b32 s50, s44, 8
    s_lshl_b32 s51, s68, 6
    s_add_u32 s50, s50, s51
    s_lshl_b32 s51, s3, 4
    s_add_u32 s69, s50, s51
    s_lshl_b32 s52, s69, 10
    v_lshrrev_b32 v12, 4, v1
    v_lshlrev_b32 v12, 12, v12
    v_and_b32 v13, 15, v1
    v_lshl_add_u32 v12, v13, 4, v12
    v_add_u32 v12, s52, v12
    s_lshr_b32 s50, s44, 1
    s_lshl_b32 s50, s50, 2
    s_add_u32 s50, s50, s68
    s_min_u32 s50, s50, 13
    s_lshr_b32 s75, s50, 1
    s_lshl_b32 s75, s75, 2
    s_and_b32 s51, s44, 1
    s_mul_i32 s51, s51, 14
    s_add_u32 s70, s50, s51
    s_and_b32 s50, s3, 1
    s_mul_i32 s50, s50, 28672
    s_lshl_b32 s51, s70, 7
    s_add_u32 s50, s50, s51
    v_lshrrev_b32 v13, 3, v1
    v_mul_u32_u24 v13, 3584, v13
    v_and_b32 v14, 7, v1
    v_lshl_add_u32 v13, v14, 4, v13
    v_add_u32 v13, s50, v13
    s_mov_b32 s14, 1835008
    s_mov_b32 s15, 0x20000
    s_cmp_ge_u32 s3, 2
    s_waitcnt lgkmcnt(0)
    s_cselect_b32 s12, s92, s90
    s_cselect_b32 s13, s93, s91
    s_mov_b32 s8, s76
    s_mov_b32 s9, s77
    s_mov_b32 s10, 2097152
    s_mov_b32 s11, 0x20000
    buffer_load_dwordx4 v[68:71], v12, s[8:11], 0 offen offset:256
    buffer_load_dwordx4 v[84:87], v12, s[8:11], 0 offen offset:1280
    buffer_load_dwordx4 v[100:103], v12, s[8:11], 0 offen offset:2304
    buffer_load_dwordx4 v[116:119], v12, s[8:11], 0 offen offset:3328
    buffer_load_dwordx4 v[72:75], v12, s[8:11], 0 offen offset:512
    buffer_load_dwordx4 v[88:91], v12, s[8:11], 0 offen offset:1536
    buffer_load_dwordx4 v[104:107], v12, s[8:11], 0 offen offset:2560
    buffer_load_dwordx4 v[120:123], v12, s[8:11], 0 offen offset:3584
    buffer_load_dwordx4 v[76:79], v12, s[8:11], 0 offen offset:768
    buffer_load_dwordx4 v[92:95], v12, s[8:11], 0 offen offset:1792
    buffer_load_dwordx4 v[108:111], v12, s[8:11], 0 offen offset:2816
    buffer_load_dwordx4 v[124:127], v12, s[8:11], 0 offen offset:3840
    s_lshr_b32 s0, s3, 1
    s_and_b32 s50, s62, 1
    s_xor_b32 s0, s0, s50
    s_cmp_eq_u32 s62, 7
    s_cselect_b32 s1, 0, s62
    s_load_dword s48, s[100:101], 0
    s_lshl_b32 s50, s61, 2
    s_load_dword s60, s[86:87], s50
    s_mov_b32 s24, s78
    s_mov_b32 s25, s79
    s_mov_b32 s26, 2097152
    s_mov_b32 s27, 0x20000
    s_mov_b32 s28, s80
    s_mov_b32 s29, s81
    s_mov_b32 s30, 2097152
    s_mov_b32 s31, 0x20000
    s_mov_b32 s40, s82
    s_mov_b32 s41, s83
    s_mov_b32 s42, 4096
    s_mov_b32 s43, 0x20000
    s_mov_b32 s16, s94
    s_mov_b32 s17, s95
    s_mov_b32 s18, 1835008
    s_mov_b32 s19, 0x20000
    s_mov_b32 s20, s100
    s_mov_b32 s21, s101
    s_mov_b32 s22, 33554432
    s_mov_b32 s23, 0x20000
    s_mov_b32 s32, s84
    s_mov_b32 s33, s85
    s_mov_b32 s34, 2097152
    s_mov_b32 s35, 0x20000
    s_mov_b32 s36, s96
    s_mov_b32 s37, s97
    s_mov_b32 s38, 2097152
    s_mov_b32 s39, 0x20000
    v_lshrrev_b32 v2, 5, v1
    v_lshlrev_b32 v2, 30, v2
    v_lshl_add_u32 v2, v1, 2, v2
    s_lshl_b32 s50, s3, 1
    s_sub_u32 s50, 7, s50
    v_lshrrev_b32 v5, 5, v1
    v_sub_u32 v152, s50, v5
    v_and_b32 v8, 7, v1
    v_xor_b32 v152, v152, v8
    v_lshlrev_b32 v154, 4, v8
    v_and_b32 v8, 31, v1
    v_lshl_add_u32 v153, v8, 3, v152
    v_lshlrev_b32 v152, 4, v152
    v_lshl_add_u32 v152, v8, 8, v152
    v_add_u32 v152, 98304, v152
    v_lshlrev_b32 v153, 2, v153
    v_add_u32 v153, 106496, v153
    v_lshrrev_b32 v6, 3, v0
    v_lshl_add_u32 v154, v6, 8, v154
    v_add_u32 v154, 98304, v154
    v_xor_b32 v155, v6, v0
    v_and_b32 v155, 7, v155
    v_lshlrev_b32 v155, 4, v155
    v_mul_u32_u24 v6, 12288, v6
    v_add_u32 v155, v155, v6
    v_lshlrev_b32 v156, 2, v0
    v_add_u32 v156, 106496, v156
    s_lshl_b32 s50, s45, 16
    s_lshl_b32 s51, s3, 14
    s_add_u32 s50, s50, s51
    s_lshl_b32 s51, s44, 7
    s_add_u32 s50, s50, s51
    s_lshl_b32 s65, s44, 9
    v_lshlrev_b32 v5, 13, v5
    v_lshl_add_u32 v5, v8, 2, v5
    v_add_u32 v5, s50, v5
    v_add_u32 v6, 0x1000, v5
    v_subrev_u32 v7, 0x1000, v5
    v_lshlrev_b32 v8, 4, v8
    s_mul_i32 s64, s44, 393216
    s_mul_i32 s51, s45, 384
    s_sub_u32 s64, s64, s51
    s_add_u32 s64, s64, 1060480
    buffer_load_dwordx4 v[36:39], v8, s[40:43], s65 offen
    buffer_load_dword v14, v7, s[24:27], 0 offen offset:0 nt
    buffer_load_dword v15, v7, s[24:27], 0 offen offset:1024 nt
    buffer_load_dword v16, v7, s[24:27], 0 offen offset:2048 nt
    buffer_load_dword v17, v7, s[24:27], 0 offen offset:3072 nt
    buffer_load_dword v18, v5, s[24:27], 0 offen offset:0 nt
    buffer_load_dword v19, v5, s[24:27], 0 offen offset:1024 nt
    buffer_load_dword v20, v5, s[24:27], 0 offen offset:2048 nt
    buffer_load_dword v21, v5, s[24:27], 0 offen offset:3072 nt
    buffer_load_dword v22, v6, s[24:27], 0 offen offset:0 nt
    buffer_load_dword v23, v6, s[24:27], 0 offen offset:1024 nt
    buffer_load_dword v24, v6, s[24:27], 0 offen offset:2048 nt
    buffer_load_dword v25, v6, s[24:27], 0 offen offset:3072 nt
    buffer_load_dword v26, v7, s[28:31], 0 offen offset:3072 nt
    buffer_load_dword v27, v5, s[28:31], 0 offen offset:0 nt
    buffer_load_dword v28, v5, s[28:31], 0 offen offset:1024 nt
    buffer_load_dword v29, v5, s[28:31], 0 offen offset:2048 nt
    buffer_load_dword v30, v5, s[28:31], 0 offen offset:3072 nt
    buffer_load_dword v31, v6, s[28:31], 0 offen offset:0 nt
    buffer_load_dword v32, v6, s[28:31], 0 offen offset:1024 nt
    buffer_load_dword v33, v6, s[28:31], 0 offen offset:2048 nt
    buffer_load_dword v34, v6, s[28:31], 0 offen offset:3072 nt
    buffer_load_dwordx4 v[64:67], v12, s[8:11], 0 offen offset:0
    buffer_load_dwordx4 v[80:83], v12, s[8:11], 0 offen offset:1024
    buffer_load_dwordx4 v[96:99], v12, s[8:11], 0 offen offset:2048
    buffer_load_dwordx4 v[112:115], v12, s[8:11], 0 offen offset:3072
    s_mov_b32 s58, 458752
    buffer_load_dwordx4 v[160:163], v13, s[12:15], s58 offen
    s_mov_b32 s58, 516096
    buffer_load_dwordx4 v[164:167], v13, s[12:15], s58 offen
    s_waitcnt lgkmcnt(0)
    s_add_u32 s48, s48, 2654435769
    v_mov_b32 v3, s48
    s_waitcnt vmcnt(6)
    v_lshlrev_b32 v40, 16, v36
    v_lshlrev_b32 v41, 16, v38
    v_and_b32 v42, s49, v36
    v_and_b32 v43, s49, v38
    v_lshlrev_b32 v44, 16, v37
    v_lshlrev_b32 v45, 16, v39
    v_and_b32 v46, s49, v37
    v_and_b32 v47, s49, v39
    s_mov_b32 s58, 573440
    buffer_load_dwordx4 v[168:171], v13, s[12:15], s58 offen
    v_lshlrev_b32 v48, 16, v14
    v_and_b32 v49, s49, v14
    v_lshlrev_b32 v50, 16, v15
    v_and_b32 v51, s49, v15
    v_lshlrev_b32 v52, 16, v16
    v_and_b32 v53, s49, v16
    v_lshlrev_b32 v54, 16, v17
    v_and_b32 v55, s49, v17
    s_mov_b32 s58, 630784
    buffer_load_dwordx4 v[172:175], v13, s[12:15], s58 offen
    v_mul_f32 v38, v54, v40
    v_mul_f32 v39, v55, v41
    v_fmac_f32 v38, v52, v42
    v_fmac_f32 v39, v53, v43
    v_fmac_f32 v38, v50, v44
    v_fmac_f32 v39, v51, v45
    v_fmac_f32 v38, v48, v46
    v_fmac_f32 v39, v49, v47
    s_mov_b32 s58, 688128
    buffer_load_dwordx4 v[176:179], v13, s[12:15], s58 offen
    v_lshlrev_b32 v9, 16, v26
    v_and_b32 v10, s49, v26
    v_mul_f32 v38, v38, v9
    v_mul_f32 v39, v39, v10
    v_cvt_pk_bf16_f32 v35, v38, v39
    v_lshlrev_b32 v48, 16, v18
    v_and_b32 v49, s49, v18
    v_mul_f32 v36, v48, v40
    s_mov_b32 s58, 745472
    buffer_load_dwordx4 v[180:183], v13, s[12:15], s58 offen
    v_mul_f32 v37, v49, v41
    v_fmac_f32 v36, v54, v42
    v_fmac_f32 v37, v55, v43
    v_fmac_f32 v36, v52, v44
    v_fmac_f32 v37, v53, v45
    v_fmac_f32 v36, v50, v46
    v_fmac_f32 v37, v51, v47
    v_lshlrev_b32 v9, 16, v27
    s_mov_b32 s58, 802816
    buffer_load_dwordx4 v[184:187], v13, s[12:15], s58 offen
    v_and_b32 v10, s49, v27
    v_mul_f32 v36, v36, v9
    v_mul_f32 v37, v37, v10
    v_lshlrev_b32 v50, 16, v19
    v_and_b32 v51, s49, v19
    v_mul_f32 v38, v50, v40
    v_mul_f32 v39, v51, v41
    v_fmac_f32 v38, v48, v42
    s_mov_b32 s58, 860160
    buffer_load_dwordx4 v[188:191], v13, s[12:15], s58 offen
    v_fmac_f32 v39, v49, v43
    v_fmac_f32 v38, v54, v44
    v_fmac_f32 v39, v55, v45
    v_fmac_f32 v38, v52, v46
    v_fmac_f32 v39, v53, v47
    v_lshlrev_b32 v9, 16, v28
    v_and_b32 v10, s49, v28
    v_mul_f32 v38, v38, v9
    s_mov_b32 s58, 917504
    buffer_load_dwordx4 v[192:195], v13, s[12:15], s58 offen
    v_mul_f32 v39, v39, v10
    v_cvt_pk_bf16_f32 v59, v38, v36
    v_cvt_pk_bf16_f32 v63, v39, v37
    v_lshlrev_b32 v52, 16, v20
    v_and_b32 v53, s49, v20
    v_mul_f32 v36, v52, v40
    v_mul_f32 v37, v53, v41
    v_fmac_f32 v36, v50, v42
    s_mov_b32 s58, 974848
    buffer_load_dwordx4 v[196:199], v13, s[12:15], s58 offen
    v_fmac_f32 v37, v51, v43
    v_fmac_f32 v36, v48, v44
    v_fmac_f32 v37, v49, v45
    v_fmac_f32 v36, v54, v46
    v_fmac_f32 v37, v55, v47
    v_lshlrev_b32 v9, 16, v29
    v_and_b32 v10, s49, v29
    v_mul_f32 v36, v36, v9
    s_mov_b32 s58, 1032192
    buffer_load_dwordx4 v[200:203], v13, s[12:15], s58 offen
    v_mul_f32 v37, v37, v10
    v_lshlrev_b32 v54, 16, v21
    v_and_b32 v55, s49, v21
    v_mul_f32 v38, v54, v40
    v_mul_f32 v39, v55, v41
    v_fmac_f32 v38, v52, v42
    v_fmac_f32 v39, v53, v43
    v_fmac_f32 v38, v50, v44
    s_mov_b32 s58, 1089536
    buffer_load_dwordx4 v[204:207], v13, s[12:15], s58 offen
    v_fmac_f32 v39, v51, v45
    v_fmac_f32 v38, v48, v46
    v_fmac_f32 v39, v49, v47
    v_lshlrev_b32 v9, 16, v30
    v_and_b32 v10, s49, v30
    v_mul_f32 v38, v38, v9
    v_mul_f32 v39, v39, v10
    v_cvt_pk_bf16_f32 v58, v38, v36
    s_mov_b32 s58, 1146880
    buffer_load_dwordx4 v[208:211], v13, s[12:15], s58 offen
    v_cvt_pk_bf16_f32 v62, v39, v37
    v_lshlrev_b32 v48, 16, v22
    v_and_b32 v49, s49, v22
    v_mul_f32 v36, v48, v40
    v_mul_f32 v37, v49, v41
    v_fmac_f32 v36, v54, v42
    v_fmac_f32 v37, v55, v43
    v_fmac_f32 v36, v52, v44
    s_mov_b32 s58, 1204224
    buffer_load_dwordx4 v[212:215], v13, s[12:15], s58 offen
    v_fmac_f32 v37, v53, v45
    v_fmac_f32 v36, v50, v46
    v_fmac_f32 v37, v51, v47
    v_lshlrev_b32 v9, 16, v31
    v_and_b32 v10, s49, v31
    v_mul_f32 v36, v36, v9
    v_mul_f32 v37, v37, v10
    v_lshlrev_b32 v50, 16, v23
    s_mov_b32 s58, 1261568
    buffer_load_dwordx4 v[216:219], v13, s[12:15], s58 offen
    v_and_b32 v51, s49, v23
    v_mul_f32 v38, v50, v40
    v_mul_f32 v39, v51, v41
    v_fmac_f32 v38, v48, v42
    v_fmac_f32 v39, v49, v43
    v_fmac_f32 v38, v54, v44
    v_fmac_f32 v39, v55, v45
    v_fmac_f32 v38, v52, v46
    s_mov_b32 s58, 1318912
    buffer_load_dwordx4 v[220:223], v13, s[12:15], s58 offen
    v_fmac_f32 v39, v53, v47
    v_lshlrev_b32 v9, 16, v32
    v_and_b32 v10, s49, v32
    v_mul_f32 v38, v38, v9
    v_mul_f32 v39, v39, v10
    v_cvt_pk_bf16_f32 v57, v38, v36
    v_cvt_pk_bf16_f32 v61, v39, v37
    v_lshlrev_b32 v52, 16, v24
    s_mov_b32 s58, 1376256
    buffer_load_dwordx4 v[224:227], v13, s[12:15], s58 offen
    v_and_b32 v53, s49, v24
    v_mul_f32 v36, v52, v40
    v_mul_f32 v37, v53, v41
    v_fmac_f32 v36, v50, v42
    v_fmac_f32 v37, v51, v43
    v_fmac_f32 v36, v48, v44
    v_fmac_f32 v37, v49, v45
    v_fmac_f32 v36, v54, v46
    s_mov_b32 s58, 1433600
    buffer_load_dwordx4 v[228:231], v13, s[12:15], s58 offen
    v_fmac_f32 v37, v55, v47
    v_lshlrev_b32 v9, 16, v33
    v_and_b32 v10, s49, v33
    v_mul_f32 v36, v36, v9
    v_mul_f32 v37, v37, v10
    v_lshlrev_b32 v54, 16, v25
    v_and_b32 v55, s49, v25
    v_mul_f32 v38, v54, v40
    s_mov_b32 s58, 1490944
    buffer_load_dwordx4 v[232:235], v13, s[12:15], s58 offen
    v_mul_f32 v39, v55, v41
    v_fmac_f32 v38, v52, v42
    v_fmac_f32 v39, v53, v43
    v_fmac_f32 v38, v50, v44
    v_fmac_f32 v39, v51, v45
    v_fmac_f32 v38, v48, v46
    v_fmac_f32 v39, v49, v47
    v_lshlrev_b32 v9, 16, v34
    s_mov_b32 s58, 1548288
    buffer_load_dwordx4 v[236:239], v13, s[12:15], s58 offen
    v_and_b32 v10, s49, v34
    v_mul_f32 v38, v38, v9
    v_mul_f32 v39, v39, v10
    v_cvt_pk_bf16_f32 v56, v38, v36
    v_cvt_pk_bf16_f32 v60, v39, v37
    ds_write_b128 v152, v[56:59]
    ds_write_b128 v152, v[60:63] offset:128
    ds_write_b32 v153, v35
    s_mov_b32 s58, 1605632
    buffer_load_dwordx4 v[240:243], v13, s[12:15], s58 offen
    s_waitcnt lgkmcnt(0)
    s_barrier
    ds_read_b128 v[56:59], v154
    ds_read_b128 v[60:63], v154 offset:128
    ds_read_b32 v50, v156
    s_waitcnt lgkmcnt(0)
    v_mov_b32 v48, v59
    v_mov_b32 v49, v63
    v_mov_b32 v51, s48
    v_mov_b32 v59, s48
    v_mov_b32 v63, s48
    buffer_store_dwordx4 v[56:59], v155, s[20:23], s64 offen offset:0 sc1
    buffer_store_dwordx4 v[60:63], v155, s[20:23], s64 offen offset:128 sc1
    buffer_store_dwordx4 v[48:51], v155, s[20:23], s64 offen offset:256 sc1
    s_nop 0
    s_nop 1
    v_and_b32 v9, 15, v1
    v_lshrrev_b32 v10, 1, v9
    v_and_b32 v9, 1, v9
    v_lshlrev_b32 v9, 4, v9
    v_mov_b32 v11, 0x3f80
    v_lshlrev_b32 v11, v9, v11
    v_cmp_eq_u32 vcc, 0, v10
    s_nop 1
    v_cndmask_b32 v40, 0, v11, vcc
    v_cmp_eq_u32 vcc, 1, v10
    s_nop 1
    v_cndmask_b32 v41, 0, v11, vcc
    v_cmp_eq_u32 vcc, 2, v10
    s_nop 1
    v_cndmask_b32 v42, 0, v11, vcc
    v_cmp_eq_u32 vcc, 3, v10
    s_nop 1
    v_cndmask_b32 v43, 0, v11, vcc
    v_mov_b32 v48, 0
    v_mov_b32 v49, 0
    v_mov_b32 v50, 0
    v_mov_b32 v51, 0
    v_mov_b32 v52, 0
    v_mov_b32 v53, 0
    v_mov_b32 v54, 0
    v_mov_b32 v55, 0
    s_mov_b32 s71, 0x3f803f80
    s_mov_b32 s58, 1662976
    buffer_load_dwordx4 v[244:247], v13, s[12:15], s58 offen
    v_dot2_f32_bf16 v48, v68, s71, v48
    v_dot2_f32_bf16 v49, v68, v68, v49
    v_dot2_f32_bf16 v48, v69, s71, v48
    v_dot2_f32_bf16 v49, v69, v69, v49
    v_dot2_f32_bf16 v48, v70, s71, v48
    v_dot2_f32_bf16 v49, v70, v70, v49
    v_dot2_f32_bf16 v48, v71, s71, v48
    v_dot2_f32_bf16 v49, v71, v71, v49
    s_mov_b32 s58, 1720320
    buffer_load_dwordx4 v[248:251], v13, s[12:15], s58 offen
    v_dot2_f32_bf16 v50, v84, s71, v50
    v_dot2_f32_bf16 v51, v84, v84, v51
    v_dot2_f32_bf16 v50, v85, s71, v50
    v_dot2_f32_bf16 v51, v85, v85, v51
    v_dot2_f32_bf16 v50, v86, s71, v50
    v_dot2_f32_bf16 v51, v86, v86, v51
    v_dot2_f32_bf16 v50, v87, s71, v50
    v_dot2_f32_bf16 v51, v87, v87, v51
    s_mov_b32 s58, 1777664
    buffer_load_dwordx4 v[252:255], v13, s[12:15], s58 offen
    v_dot2_f32_bf16 v52, v100, s71, v52
    v_dot2_f32_bf16 v53, v100, v100, v53
    v_dot2_f32_bf16 v52, v101, s71, v52
    v_dot2_f32_bf16 v53, v101, v101, v53
    v_dot2_f32_bf16 v52, v102, s71, v52
    v_dot2_f32_bf16 v53, v102, v102, v53
    v_dot2_f32_bf16 v52, v103, s71, v52
    v_dot2_f32_bf16 v53, v103, v103, v53
    s_mov_b32 s58, 0
    buffer_load_dwordx4 v[128:131], v13, s[12:15], s58 offen
    v_dot2_f32_bf16 v54, v116, s71, v54
    v_dot2_f32_bf16 v55, v116, v116, v55
    v_dot2_f32_bf16 v54, v117, s71, v54
    v_dot2_f32_bf16 v55, v117, v117, v55
    v_dot2_f32_bf16 v54, v118, s71, v54
    v_dot2_f32_bf16 v55, v118, v118, v55
    v_dot2_f32_bf16 v54, v119, s71, v54
    v_dot2_f32_bf16 v55, v119, v119, v55
    s_mov_b32 s58, 57344
    buffer_load_dwordx4 v[132:135], v13, s[12:15], s58 offen
    v_dot2_f32_bf16 v48, v72, s71, v48
    v_dot2_f32_bf16 v49, v72, v72, v49
    v_dot2_f32_bf16 v48, v73, s71, v48
    v_dot2_f32_bf16 v49, v73, v73, v49
    v_dot2_f32_bf16 v48, v74, s71, v48
    v_dot2_f32_bf16 v49, v74, v74, v49
    v_dot2_f32_bf16 v48, v75, s71, v48
    v_dot2_f32_bf16 v49, v75, v75, v49
    s_mov_b32 s58, 114688
    buffer_load_dwordx4 v[136:139], v13, s[12:15], s58 offen
    v_dot2_f32_bf16 v50, v88, s71, v50
    v_dot2_f32_bf16 v51, v88, v88, v51
    v_dot2_f32_bf16 v50, v89, s71, v50
    v_dot2_f32_bf16 v51, v89, v89, v51
    v_dot2_f32_bf16 v50, v90, s71, v50
    v_dot2_f32_bf16 v51, v90, v90, v51
    v_dot2_f32_bf16 v50, v91, s71, v50
    v_dot2_f32_bf16 v51, v91, v91, v51
    s_mov_b32 s58, 172032
    buffer_load_dwordx4 v[140:143], v13, s[12:15], s58 offen
    v_dot2_f32_bf16 v52, v104, s71, v52
    v_dot2_f32_bf16 v53, v104, v104, v53
    v_dot2_f32_bf16 v52, v105, s71, v52
    v_dot2_f32_bf16 v53, v105, v105, v53
    v_dot2_f32_bf16 v52, v106, s71, v52
    v_dot2_f32_bf16 v53, v106, v106, v53
    v_dot2_f32_bf16 v52, v107, s71, v52
    v_dot2_f32_bf16 v53, v107, v107, v53
    s_mov_b32 s58, 229376
    buffer_load_dwordx4 v[144:147], v13, s[12:15], s58 offen
    v_dot2_f32_bf16 v54, v120, s71, v54
    v_dot2_f32_bf16 v55, v120, v120, v55
    v_dot2_f32_bf16 v54, v121, s71, v54
    v_dot2_f32_bf16 v55, v121, v121, v55
    v_dot2_f32_bf16 v54, v122, s71, v54
    v_dot2_f32_bf16 v55, v122, v122, v55
    v_dot2_f32_bf16 v54, v123, s71, v54
    v_dot2_f32_bf16 v55, v123, v123, v55
    s_mov_b32 s58, 286720
    buffer_load_dwordx4 v[148:151], v13, s[12:15], s58 offen
    v_dot2_f32_bf16 v48, v76, s71, v48
    v_dot2_f32_bf16 v49, v76, v76, v49
    v_dot2_f32_bf16 v48, v77, s71, v48
    v_dot2_f32_bf16 v49, v77, v77, v49
    v_dot2_f32_bf16 v48, v78, s71, v48
    v_dot2_f32_bf16 v49, v78, v78, v49
    v_dot2_f32_bf16 v48, v79, s71, v48
    v_dot2_f32_bf16 v49, v79, v79, v49
    s_mov_b32 s58, 344064
    buffer_load_dwordx4 v[152:155], v13, s[12:15], s58 offen
    v_dot2_f32_bf16 v50, v92, s71, v50
    v_dot2_f32_bf16 v51, v92, v92, v51
    v_dot2_f32_bf16 v50, v93, s71, v50
    v_dot2_f32_bf16 v51, v93, v93, v51
    v_dot2_f32_bf16 v50, v94, s71, v50
    v_dot2_f32_bf16 v51, v94, v94, v51
    v_dot2_f32_bf16 v50, v95, s71, v50
    v_dot2_f32_bf16 v51, v95, v95, v51
    s_mov_b32 s58, 401408
    buffer_load_dwordx4 v[156:159], v13, s[12:15], s58 offen
    v_dot2_f32_bf16 v52, v108, s71, v52
    v_dot2_f32_bf16 v53, v108, v108, v53
    v_dot2_f32_bf16 v52, v109, s71, v52
    v_dot2_f32_bf16 v53, v109, v109, v53
    v_dot2_f32_bf16 v52, v110, s71, v52
    v_dot2_f32_bf16 v53, v110, v110, v53
    v_dot2_f32_bf16 v52, v111, s71, v52
    v_dot2_f32_bf16 v53, v111, v111, v53
    v_dot2_f32_bf16 v54, v124, s71, v54
    v_dot2_f32_bf16 v55, v124, v124, v55
    v_dot2_f32_bf16 v54, v125, s71, v54
    v_dot2_f32_bf16 v55, v125, v125, v55
    v_dot2_f32_bf16 v54, v126, s71, v54
    v_dot2_f32_bf16 v55, v126, v126, v55
    v_dot2_f32_bf16 v54, v127, s71, v54
    v_dot2_f32_bf16 v55, v127, v127, v55
    s_waitcnt vmcnt(38)
    v_dot2_f32_bf16 v48, v64, s71, v48
    v_dot2_f32_bf16 v49, v64, v64, v49
    v_dot2_f32_bf16 v48, v65, s71, v48
    v_dot2_f32_bf16 v49, v65, v65, v49
    v_dot2_f32_bf16 v48, v66, s71, v48
    v_dot2_f32_bf16 v49, v66, v66, v49
    v_dot2_f32_bf16 v48, v67, s71, v48
    v_dot2_f32_bf16 v49, v67, v67, v49
    s_waitcnt vmcnt(37)
    v_dot2_f32_bf16 v50, v80, s71, v50
    v_dot2_f32_bf16 v51, v80, v80, v51
    v_dot2_f32_bf16 v50, v81, s71, v50
    v_dot2_f32_bf16 v51, v81, v81, v51
    v_dot2_f32_bf16 v50, v82, s71, v50
    v_dot2_f32_bf16 v51, v82, v82, v51
    v_dot2_f32_bf16 v50, v83, s71, v50
    v_dot2_f32_bf16 v51, v83, v83, v51
    s_waitcnt vmcnt(36)
    v_dot2_f32_bf16 v52, v96, s71, v52
    v_dot2_f32_bf16 v53, v96, v96, v53
    v_dot2_f32_bf16 v52, v97, s71, v52
    v_dot2_f32_bf16 v53, v97, v97, v53
    v_dot2_f32_bf16 v52, v98, s71, v52
    v_dot2_f32_bf16 v53, v98, v98, v53
    v_dot2_f32_bf16 v52, v99, s71, v52
    v_dot2_f32_bf16 v53, v99, v99, v53
    s_waitcnt vmcnt(35)
    v_dot2_f32_bf16 v54, v112, s71, v54
    v_dot2_f32_bf16 v55, v112, v112, v55
    v_dot2_f32_bf16 v54, v113, s71, v54
    v_dot2_f32_bf16 v55, v113, v113, v55
    v_dot2_f32_bf16 v54, v114, s71, v54
    v_dot2_f32_bf16 v55, v114, v114, v55
    v_dot2_f32_bf16 v54, v115, s71, v54
    v_dot2_f32_bf16 v55, v115, v115, v55
    s_waitcnt vmcnt(34)
    v_mfma_f32_16x16x32_bf16 v[44:47], v[160:163], v[40:43], 0
    s_waitcnt vmcnt(33)
    v_mfma_f32_16x16x32_bf16 v[44:47], v[164:167], v[40:43], v[44:47]
    s_waitcnt vmcnt(32)
    v_mfma_f32_16x16x32_bf16 v[44:47], v[168:171], v[40:43], v[44:47]
    s_waitcnt vmcnt(31)
    v_mfma_f32_16x16x32_bf16 v[44:47], v[172:175], v[40:43], v[44:47]
    s_waitcnt vmcnt(30)
    v_mfma_f32_16x16x32_bf16 v[44:47], v[176:179], v[40:43], v[44:47]
    s_waitcnt vmcnt(29)
    v_mfma_f32_16x16x32_bf16 v[44:47], v[180:183], v[40:43], v[44:47]
    s_waitcnt vmcnt(28)
    v_mfma_f32_16x16x32_bf16 v[44:47], v[184:187], v[40:43], v[44:47]
    s_waitcnt vmcnt(27)
    v_mfma_f32_16x16x32_bf16 v[44:47], v[188:191], v[40:43], v[44:47]
    s_waitcnt vmcnt(26)
    v_mfma_f32_16x16x32_bf16 v[44:47], v[192:195], v[40:43], v[44:47]
    s_waitcnt vmcnt(25)
    v_mfma_f32_16x16x32_bf16 v[44:47], v[196:199], v[40:43], v[44:47]
    s_waitcnt vmcnt(24)
    v_mfma_f32_16x16x32_bf16 v[44:47], v[200:203], v[40:43], v[44:47]
    s_waitcnt vmcnt(23)
    v_mfma_f32_16x16x32_bf16 v[44:47], v[204:207], v[40:43], v[44:47]
    s_waitcnt vmcnt(22)
    v_mfma_f32_16x16x32_bf16 v[44:47], v[208:211], v[40:43], v[44:47]
    s_waitcnt vmcnt(21)
    v_mfma_f32_16x16x32_bf16 v[44:47], v[212:215], v[40:43], v[44:47]
    s_waitcnt vmcnt(20)
    v_mfma_f32_16x16x32_bf16 v[44:47], v[216:219], v[40:43], v[44:47]
    s_waitcnt vmcnt(19)
    v_mfma_f32_16x16x32_bf16 v[44:47], v[220:223], v[40:43], v[44:47]
    s_waitcnt vmcnt(18)
    v_mfma_f32_16x16x32_bf16 v[44:47], v[224:227], v[40:43], v[44:47]
    s_waitcnt vmcnt(17)
    v_mfma_f32_16x16x32_bf16 v[44:47], v[228:231], v[40:43], v[44:47]
    s_waitcnt vmcnt(16)
    v_mfma_f32_16x16x32_bf16 v[44:47], v[232:235], v[40:43], v[44:47]
    s_waitcnt vmcnt(15)
    v_mfma_f32_16x16x32_bf16 v[44:47], v[236:239], v[40:43], v[44:47]
    s_waitcnt vmcnt(14)
    v_mfma_f32_16x16x32_bf16 v[44:47], v[240:243], v[40:43], v[44:47]
    s_waitcnt vmcnt(10)
    v_mfma_f32_16x16x32_bf16 v[44:47], v[244:247], v[40:43], v[44:47]
    s_waitcnt vmcnt(9)
    v_mfma_f32_16x16x32_bf16 v[44:47], v[248:251], v[40:43], v[44:47]
    s_waitcnt vmcnt(8)
    v_mfma_f32_16x16x32_bf16 v[44:47], v[252:255], v[40:43], v[44:47]
    s_waitcnt vmcnt(7)
    v_mfma_f32_16x16x32_bf16 v[44:47], v[128:131], v[40:43], v[44:47]
    s_waitcnt vmcnt(6)
    v_mfma_f32_16x16x32_bf16 v[44:47], v[132:135], v[40:43], v[44:47]
    s_waitcnt vmcnt(5)
    v_mfma_f32_16x16x32_bf16 v[44:47], v[136:139], v[40:43], v[44:47]
    s_waitcnt vmcnt(4)
    v_mfma_f32_16x16x32_bf16 v[44:47], v[140:143], v[40:43], v[44:47]
    s_waitcnt vmcnt(3)
    v_mfma_f32_16x16x32_bf16 v[44:47], v[144:147], v[40:43], v[44:47]
    s_waitcnt vmcnt(2)
    v_mfma_f32_16x16x32_bf16 v[44:47], v[148:151], v[40:43], v[44:47]
    s_waitcnt vmcnt(1)
    v_mfma_f32_16x16x32_bf16 v[44:47], v[152:155], v[40:43], v[44:47]
    s_waitcnt vmcnt(0)
    v_mfma_f32_16x16x32_bf16 v[44:47], v[156:159], v[40:43], v[44:47]
    v_lshrrev_b32 v9, 5, v1
    v_lshlrev_b32 v9, 8, v9
    v_bfe_u32 v10, v1, 4, 1
    v_lshl_add_u32 v9, v10, 7, v9
    v_and_b32 v10, 7, v1
    v_lshl_add_u32 v9, v10, 2, v9
    v_bfe_u32 v10, v1, 3, 1
    v_lshl_add_u32 v9, v10, 12, v9
    s_lshl_b32 s50, s3, 9
    v_add_u32 v9, s50, v9
    ds_write_b32 v9, v44 offset:0
    ds_write_b32 v9, v45 offset:32
    ds_write_b32 v9, v46 offset:64
    ds_write_b32 v9, v47 offset:96
    v_add_f32_dpp v48, v48, v48 row_ror:8 row_mask:0xf bank_mask:0xf
    v_add_f32_dpp v49, v49, v49 row_ror:8 row_mask:0xf bank_mask:0xf
    v_add_f32_dpp v50, v50, v50 row_ror:8 row_mask:0xf bank_mask:0xf
    v_add_f32_dpp v51, v51, v51 row_ror:8 row_mask:0xf bank_mask:0xf
    v_add_f32_dpp v52, v52, v52 row_ror:8 row_mask:0xf bank_mask:0xf
    v_add_f32_dpp v53, v53, v53 row_ror:8 row_mask:0xf bank_mask:0xf
    v_add_f32_dpp v54, v54, v54 row_ror:8 row_mask:0xf bank_mask:0xf
    v_add_f32_dpp v55, v55, v55 row_ror:8 row_mask:0xf bank_mask:0xf
    v_add_f32_dpp v48, v48, v48 row_ror:4 row_mask:0xf bank_mask:0xf
    v_add_f32_dpp v49, v49, v49 row_ror:4 row_mask:0xf bank_mask:0xf
    v_add_f32_dpp v50, v50, v50 row_ror:4 row_mask:0xf bank_mask:0xf
    v_add_f32_dpp v51, v51, v51 row_ror:4 row_mask:0xf bank_mask:0xf
    v_add_f32_dpp v52, v52, v52 row_ror:4 row_mask:0xf bank_mask:0xf
    v_add_f32_dpp v53, v53, v53 row_ror:4 row_mask:0xf bank_mask:0xf
    v_add_f32_dpp v54, v54, v54 row_ror:4 row_mask:0xf bank_mask:0xf
    v_add_f32_dpp v55, v55, v55 row_ror:4 row_mask:0xf bank_mask:0xf
    v_add_f32_dpp v48, v48, v48 row_ror:2 row_mask:0xf bank_mask:0xf
    v_add_f32_dpp v49, v49, v49 row_ror:2 row_mask:0xf bank_mask:0xf
    v_add_f32_dpp v50, v50, v50 row_ror:2 row_mask:0xf bank_mask:0xf
    v_add_f32_dpp v51, v51, v51 row_ror:2 row_mask:0xf bank_mask:0xf
    v_add_f32_dpp v52, v52, v52 row_ror:2 row_mask:0xf bank_mask:0xf
    v_add_f32_dpp v53, v53, v53 row_ror:2 row_mask:0xf bank_mask:0xf
    v_add_f32_dpp v54, v54, v54 row_ror:2 row_mask:0xf bank_mask:0xf
    v_add_f32_dpp v55, v55, v55 row_ror:2 row_mask:0xf bank_mask:0xf
    v_add_f32_dpp v48, v48, v48 row_ror:1 row_mask:0xf bank_mask:0xf
    v_add_f32_dpp v49, v49, v49 row_ror:1 row_mask:0xf bank_mask:0xf
    v_add_f32_dpp v50, v50, v50 row_ror:1 row_mask:0xf bank_mask:0xf
    v_add_f32_dpp v51, v51, v51 row_ror:1 row_mask:0xf bank_mask:0xf
    v_add_f32_dpp v52, v52, v52 row_ror:1 row_mask:0xf bank_mask:0xf
    v_add_f32_dpp v53, v53, v53 row_ror:1 row_mask:0xf bank_mask:0xf
    v_add_f32_dpp v54, v54, v54 row_ror:1 row_mask:0xf bank_mask:0xf
    v_add_f32_dpp v55, v55, v55 row_ror:1 row_mask:0xf bank_mask:0xf
    s_waitcnt lgkmcnt(0)
    s_barrier
    v_bfe_u32 v10, v0, 6, 1
    v_lshlrev_b32 v9, 10, v10
    v_lshl_add_u32 v9, v1, 2, v9
    ds_read_b32 v56, v9 offset:0
    ds_read_b32 v57, v9 offset:256
    ds_read_b32 v58, v9 offset:512
    ds_read_b32 v59, v9 offset:768
    v_lshrrev_b32 v9, 4, v1
    v_lshlrev_b32 v9, 9, v9
    v_lshl_add_u32 v9, v10, 8, v9
    v_and_b32 v11, 15, v1
    v_lshl_add_u32 v9, v11, 4, v9
    v_lshrrev_b32 v11, 7, v0
    v_lshl_add_u32 v9, v11, 30, v9
    s_lshl_b32 s50, s70, 11
    s_add_u32 s50, s50, 196608
    s_waitcnt lgkmcnt(0)
    v_add_f32 v56, v56, v57
    v_add_f32 v58, v58, v59
    v_add_f32 v56, v56, v58
    v_and_b32 v58, s49, v56
    v_sub_f32 v56, v56, v58
    v_and_b32 v59, s49, v56
    v_sub_f32 v56, v56, v59
    v_lshrrev_b32 v57, 16, v56
    v_lshrrev_b32 v58, 16, v58
    v_or_b32 v56, v58, v59
    v_mov_b32 v58, s48
    v_mov_b32 v59, s48
    buffer_store_dwordx4 v[56:59], v9, s[20:23], s50 offen sc1
    v_and_b32 v9, 3, v1
    v_cmp_eq_u32 vcc, 1, v9
    s_nop 1
    v_cndmask_b32 v48, v48, v50, vcc
    v_cndmask_b32 v49, v49, v51, vcc
    v_cmp_eq_u32 vcc, 2, v9
    s_nop 1
    v_cndmask_b32 v48, v48, v52, vcc
    v_cndmask_b32 v49, v49, v53, vcc
    v_cmp_eq_u32 vcc, 3, v9
    s_nop 1
    v_cndmask_b32 v48, v48, v54, vcc
    v_cndmask_b32 v49, v49, v55, vcc
    v_mul_f32 v60, 0x3b000000, v48
    v_mul_f32 v40, 0x3b000000, v49
    v_fma_f32 v40, -v60, v60, v40
    v_max_f32 v40, 0, v40
    v_cvt_pk_bf16_f32 v60, v60, v60
    v_and_b32 v60, s49, v60
    v_cvt_pk_bf16_f32 v40, v40, v40
    v_and_b32 v40, s49, v40
    v_add_f32 v40, 0x3727c5ac, v40
    v_cvt_pk_bf16_f32 v40, v40, v40
    v_and_b32 v40, s49, v40
    v_sqrt_f32 v40, v40
    s_nop 0
    v_cvt_pk_bf16_f32 v40, v40, v40
    v_and_b32 v40, s49, v40
    v_rcp_f32 v62, v40
    v_mov_b32 v61, s48
    v_mov_b32 v63, s48
    v_lshrrev_b32 v10, 4, v1
    v_lshl_add_u32 v9, v10, 2, v9
    v_lshlrev_b32 v9, 4, v9
    s_lshl_b32 s50, s69, 4
    s_add_u32 s50, s50, 65536
    v_and_b32 v10, 12, v1
    v_lshl_add_u32 v9, v10, 27, v9
    buffer_store_dwordx4 v[60:63], v9, s[20:23], s50 offen sc1
    v_mul_f32 v44, -0.5, v60
    v_lshrrev_b32 v45, 16, v44
    v_and_or_b32 v44, v44, s49, v45
    v_mov_b32 v46, s48
    v_mov_b32 v47, s48
    s_add_u32 s50, s50, 65536
    buffer_store_dwordx4 v[44:47], v9, s[20:23], s50 offen sc1
    s_nop 1
    s_lshr_b32 s50, s3, 1
    s_mul_i32 s68, s50, 16656
    s_add_u32 s68, s68, 116608
    s_and_b32 s69, s3, 1
    s_mul_i32 s50, s50, 9152
    s_lshl_b32 s51, s69, 8
    s_add_u32 s50, s50, s51
    s_add_u32 s50, s50, 98752
    s_add_u32 s51, s51, s68
    v_and_b32 v9, 1, v1
    v_mul_u32_u24 v9, 4576, v9
    v_bfe_u32 v10, v1, 1, 3
    v_lshlrev_b32 v10, 6, v10
    v_sub_u32 v9, v9, v10
    v_lshrrev_b32 v11, 4, v1
    v_lshl_add_u32 v9, v11, 4, v9
    v_add_u32 v41, s50, v9
    v_and_b32 v9, 15, v1
    v_add_u32 v9, 1, v9
    v_lshrrev_b32 v10, 2, v9
    v_add_u32 v10, v10, v11
    v_and_b32 v9, 3, v9
    v_min_u32 v14, 1, v9
    v_add_u32 v10, v10, v14
    v_mul_u32_u24 v9, 4160, v9
    v_lshl_add_u32 v9, v10, 4, v9
    v_add_u32 v42, s51, v9
    v_bfe_u32 v9, v1, 4, 1
    v_lshl_add_u32 v9, s69, 1, v9
    v_and_b32 v10, 15, v1
    v_add_u32 v11, v9, v10
    v_mul_u32_u24 v14, 4160, v9
    v_min_u32 v9, 1, v9
    v_cmp_gt_u32 vcc, 16, v11
    v_lshl_add_u32 v14, v9, 4, v14
    v_subrev_u32 v11, 16, v11
    v_lshlrev_b32 v11, 2, v11
    v_mov_b32 v9, 0x40000000
    v_cndmask_b32 v11, v11, v9, vcc
    v_lshl_add_u32 v14, v10, 2, v14
    v_add_u32 v14, s68, v14
    v_and_b32 v12, 31, v1
    v_lshlrev_b32 v13, 4, v12
    v_lshlrev_b32 v12, 3, v12
    s_lshr_b32 s64, s3, 1
    s_lshl_b32 s57, s61, 1
    s_add_u32 s57, s57, s64
    s_lshl_b32 s57, s57, 12
    s_mov_b32 exec_hi, 0
    buffer_load_dword v11, v11, s[32:35], s57 offen
    s_mov_b32 exec_hi, -1
    s_lshl_b32 s64, s69, 3
    s_add_u32 s57, s57, s64
    s_mul_i32 s64, s69, 8336
    s_add_u32 s64, s64, s68
    s_add_u32 m0, s64, 64
    s_nop 0
    buffer_load_dwordx4 v4, s[32:35], s57 offen offset:0 lds
    buffer_load_dwordx4 v4, s[32:35], s57 offen offset:1024 lds
    buffer_load_dwordx4 v4, s[32:35], s57 offen offset:2048 lds
    buffer_load_dwordx4 v4, s[32:35], s57 offen offset:3072 lds
    s_mul_i32 s64, s69, 8320
    s_add_u32 s64, s64, s68
    s_add_u32 s57, s57, 4
    s_add_u32 m0, s64, 4240
    s_nop 0
    buffer_load_dwordx4 v4, s[32:35], s57 offen offset:0 lds
    buffer_load_dwordx4 v4, s[32:35], s57 offen offset:1024 lds
    buffer_load_dwordx4 v4, s[32:35], s57 offen offset:2048 lds
    buffer_load_dwordx4 v4, s[32:35], s57 offen offset:3072 lds
    s_sub_u32 s50, s2, 224
    s_lshl_b32 s50, s50, 2
    s_add_u32 s50, s50, s3
    s_mul_i32 s50, s50, 14336
    buffer_load_dwordx4 a[252:255], v4, s[16:19], s50 offen offset:0
    buffer_load_dwordx4 a[252:255], v4, s[16:19], s50 offen offset:1024
    buffer_load_dwordx4 a[252:255], v4, s[16:19], s50 offen offset:2048
    buffer_load_dwordx4 a[252:255], v4, s[16:19], s50 offen offset:3072
    s_add_u32 s50, s50, 4096
    buffer_load_dwordx4 a[252:255], v4, s[16:19], s50 offen offset:0
    buffer_load_dwordx4 a[252:255], v4, s[16:19], s50 offen offset:1024
    buffer_load_dwordx4 a[252:255], v4, s[16:19], s50 offen offset:2048
    buffer_load_dwordx4 a[252:255], v4, s[16:19], s50 offen offset:3072
    s_add_u32 s50, s50, 4096
    buffer_load_dwordx4 a[252:255], v4, s[16:19], s50 offen offset:0
    buffer_load_dwordx4 a[252:255], v4, s[16:19], s50 offen offset:1024
    buffer_load_dwordx4 a[252:255], v4, s[16:19], s50 offen offset:2048
    buffer_load_dwordx4 a[252:255], v4, s[16:19], s50 offen offset:3072
    s_add_u32 s50, s50, 4096
    buffer_load_dwordx4 a[252:255], v4, s[16:19], s50 offen offset:0
    buffer_load_dwordx4 a[252:255], v4, s[16:19], s50 offen offset:1024
    s_and_b32 s50, s44, 1
    s_mul_i32 s50, s50, 917504
    s_lshl_b32 s51, s3, 15
    s_add_u32 s50, s50, s51
    s_lshl_b32 s51, s72, 7
    s_add_u32 s50, s50, s51
    v_lshrrev_b32 v5, 3, v1
    v_lshlrev_b32 v5, 10, v5
    v_add_u32 v5, s50, v5
    v_bfe_u32 v6, v1, 4, 1
    v_lshlrev_b32 v6, 2, v6
    v_xor_b32 v6, v6, v1
    v_and_b32 v6, 7, v6
    v_lshl_add_u32 v36, v6, 4, v5
    v_add_u32 v37, 7168, v36
    v_lshrrev_b32 v5, 5, v1
    v_lshlrev_b32 v5, 9, v5
    v_bfe_u32 v6, v1, 2, 2
    v_lshl_add_u32 v5, v6, 7, v5
    v_bfe_u32 v6, v1, 4, 1
    v_lshl_add_u32 v5, v6, 5, v5
    v_and_b32 v6, 3, v1
    v_lshl_add_u32 v40, v6, 3, v5
    v_add_u32 v5, s56, v40
    s_and_b32 s50, s3, 1
    v_bfe_u32 v6, v1, 3, 1
    v_xor_b32 v6, s50, v6
    v_lshl_add_u32 v46, v6, 6, v5
    v_xor_b32 v47, 64, v46
    v_add_u32 v38, 98304, v46
    v_add_u32 v39, 98304, v47
    v_and_b32 v61, 15, v1
    v_lshlrev_b32 v60, 10, v61
    v_lshrrev_b32 v61, 5, v1
    v_lshl_add_u32 v60, v61, 4, v60
    v_bfe_u32 v61, v1, 4, 1
    v_lshl_add_u32 v60, v61, 5, v60
    v_mov_b32 v16, v60
    v_lshrrev_b32 v61, 3, v0
    v_and_b32 v62, 7, v0
    v_mul_u32_u24 v60, 12288, v61
    v_lshl_add_u32 v60, v62, 4, v60
    v_mov_b32 v18, v60
    v_and_b32 v60, 1, v61
    v_lshlrev_b32 v60, 2, v60
    v_xor_b32 v60, v60, v62
    v_lshlrev_b32 v60, 4, v60
    v_lshl_add_u32 v60, v61, 8, v60
    v_add_u32 v60, 98304, v60
    v_mov_b32 v19, v60
    v_bfe_u32 v60, v1, 3, 1
    v_xor_b32 v60, s0, v60
    v_lshl_add_u32 v60, v60, 6, v40
    s_and_b32 s50, s3, 1
    s_lshl_b32 s50, s50, 12
    s_add_u32 s50, s50, 98304
    v_add_u32 v60, s50, v60
    v_mov_b32 v20, v60
    v_lshrrev_b32 v60, 4, v1
    v_lshlrev_b32 v60, 8, v60
    v_and_b32 v61, 15, v1
    v_lshl_add_u32 v60, v61, 3, v60
    s_add_u32 s50, s55, 65536
    v_add_u32 v60, s50, v60
    v_mov_b32 v21, v60
    v_sub_u32 v61, 255, v0
    v_lshlrev_b32 v60, 5, v61
    v_add_u32 v60, 65536, v60
    v_mov_b32 v22, v60
    v_lshrrev_b32 v60, 3, v61
    v_lshlrev_b32 v60, 8, v60
    v_lshl_add_u32 v60, v61, 4, v60
    v_mov_b32 v23, v60
    v_min_u32 v60, 6, v1
    v_lshlrev_b32 v60, 9, v60
    v_mov_b32 v5, v60
    s_xor_b32 s50, s3, 1
    s_mul_i32 s50, s50, 12288
    s_add_u32 s50, s50, 114688
    v_add_u32 v60, s50, v4
    v_mov_b32 v32, v60
    s_xor_b32 s50, s3, 2
    s_mul_i32 s50, s50, 12288
    s_add_u32 s50, s50, 118784
    v_add_u32 v60, s50, v4
    v_mov_b32 v33, v60
    s_xor_b32 s50, s3, 3
    s_mul_i32 s50, s50, 12288
    s_add_u32 s50, s50, 122880
    v_add_u32 v60, s50, v4
    v_mov_b32 v34, v60
    s_mul_i32 s50, s3, 12288
    s_add_u32 s50, s50, 114688
    v_add_u32 v60, s50, v4
    v_mov_b32 v35, v60
    s_lshl_b32 s50, s3, 3
    s_and_b32 s50, s50, 16
    s_lshr_b32 s50, s60, s50
    s_and_b32 s50, s50, 0xffff
    s_bitcmp1_b32 s3, 0
    s_cselect_b32 s50, 0, s50
    v_and_b32 v9, 15, v1
    v_lshrrev_b32 v10, 4, v1
    v_lshl_add_u32 v9, v10, 2, v9
    v_mov_b32 v43, s50
    v_cmp_eq_u32 vcc, 15, v9
    s_nop 1
    v_cndmask_b32 v10, 0, v43, vcc
    v_accvgpr_write_b32 a108, v10
    v_cmp_eq_u32 vcc, 14, v9
    s_nop 1
    v_cndmask_b32 v10, 0, v43, vcc
    v_accvgpr_write_b32 a109, v10
    v_cmp_eq_u32 vcc, 13, v9
    s_nop 1
    v_cndmask_b32 v10, 0, v43, vcc
    v_accvgpr_write_b32 a110, v10
    v_cmp_eq_u32 vcc, 12, v9
    s_nop 1
    v_cndmask_b32 v10, 0, v43, vcc
    v_accvgpr_write_b32 a111, v10
    s_waitcnt lgkmcnt(0)
    s_barrier
    s_and_b32 s70, s44, 1
    s_lshl_b32 s41, s46, 1
    s_add_u32 s41, s41, s70
    s_lshl_b32 s31, s41, 1
    s_mul_i32 s25, s31, 114688
    s_xor_b32 s24, s31, 2
    s_mul_i32 s24, s24, 114688
    s_lshl_b32 s71, s47, 13
    s_add_u32 s71, s71, s56
    s_add_u32 s71, s71, 11534336
    s_add_u32 s24, s24, s71
    s_add_u32 s25, s25, s71
    s_lshl_b32 s27, s41, 12
    s_add_u32 s27, s27, 524288
    s_lshl_b32 s71, s62, 9
    s_add_u32 s26, s27, s71
    s_lshl_b32 s71, s3, 7
    s_add_u32 s26, s26, s71
    s_add_u32 s27, s27, s71
    s_add_u32 s31, s31, s0
    s_lshl_b32 s43, s31, 15
    s_lshl_b32 s71, s72, 7
    s_add_u32 s43, s43, s71
    s_and_b32 s71, s3, 1
    s_lshl_b32 s71, s71, 6
    s_add_u32 s43, s43, s71
    s_mul_i32 s70, s70, 57344
    s_add_u32 s70, s70, s56
    s_add_u32 s70, s70, 11534336
    s_xor_b32 s28, s31, 3
    s_xor_b32 s29, s31, 2
    s_xor_b32 s30, s31, 1
    s_mul_i32 s28, s28, 114688
    s_add_u32 s28, s28, s70
    s_mul_i32 s29, s29, 114688
    s_add_u32 s29, s29, s70
    s_mul_i32 s30, s30, 114688
    s_add_u32 s30, s30, s70
    s_mul_i32 s31, s31, 114688
    s_add_u32 s31, s31, s70
    s_mul_i32 s41, s41, 384
    s_mul_i32 s71, s72, 393216
    s_add_u32 s41, s41, s71
    s_add_u32 s41, s41, 4194304
    s_mul_i32 s40, s61, 12288
    s_add_u32 s40, s40, 4194304
    s_lshl_b32 s42, s2, 14
    s_add_u32 s42, s42, s54
    s_add_u32 s42, s42, 7340032
    s_add_u32 s50, s27, 0x20000
    s_mov_b64 exec, 0x7f
    buffer_load_dword a191, v5, s[20:23], s27 offen sc1
    buffer_load_dword a191, v5, s[20:23], s50 offen sc1
    s_mov_b64 exec, -1
    s_and_b32 s50, s44, 1
    s_lshl_b32 s50, s50, 1
    s_add_u32 s50, s50, s0
    s_lshl_b32 s51, s46, 2
    s_add_u32 s50, s50, s51
    s_lshl_b32 s66, s50, 9
    s_add_u32 s66, s66, 65536
    s_lshl_b32 s50, s50, 15
    s_lshl_b32 s51, s72, 7
    s_add_u32 s50, s50, s51
    s_and_b32 s51, s3, 1
    s_lshl_b32 s51, s51, 6
    s_add_u32 s50, s50, s51
    v_and_b32 v6, 31, v1
    v_lshlrev_b32 v7, 10, v6
    v_lshlrev_b32 v8, 4, v6
    v_lshrrev_b32 v6, 5, v1
    v_lshl_add_u32 v7, v6, 3, v7
    buffer_load_dwordx2 a[216:217], v7, s[8:11], s50 offen offset:0
    buffer_load_dwordx2 a[218:219], v7, s[8:11], s50 offen offset:16
    buffer_load_dwordx2 a[220:221], v7, s[8:11], s50 offen offset:32
    buffer_load_dwordx2 a[222:223], v7, s[8:11], s50 offen offset:48
    buffer_load_dwordx4 v[84:87], v8, s[20:23], s66 offen sc1
    s_add_u32 m0, s56, 151552
    s_add_u32 s59, s1, 0
    s_sub_u32 s51, s59, 7
    s_cselect_b32 s59, s59, s51
    s_lshl_b32 s59, s59, 17
    buffer_load_dwordx4 v36, s[16:19], s59 offen offset:0 lds
    buffer_load_dwordx4 v37, s[16:19], s59 offen offset:1024 lds
    s_add_u32 m0, s56, 0
    s_add_u32 s59, s59, 16384
    buffer_load_dwordx4 v36, s[16:19], s59 offen offset:0 lds
    buffer_load_dwordx4 v37, s[16:19], s59 offen offset:1024 lds
    s_add_u32 m0, s56, 8192
    s_add_u32 s59, s1, 1
    s_sub_u32 s51, s59, 7
    s_cselect_b32 s59, s59, s51
    s_lshl_b32 s59, s59, 17
    buffer_load_dwordx4 v36, s[16:19], s59 offen offset:0 lds
    buffer_load_dwordx4 v37, s[16:19], s59 offen offset:1024 lds
    s_add_u32 m0, s56, 16384
    s_add_u32 s59, s59, 16384
    buffer_load_dwordx4 v36, s[16:19], s59 offen offset:0 lds
    buffer_load_dwordx4 v37, s[16:19], s59 offen offset:1024 lds
    s_add_u32 m0, s56, 24576
    s_add_u32 s59, s1, 2
    s_sub_u32 s51, s59, 7
    s_cselect_b32 s59, s59, s51
    s_lshl_b32 s59, s59, 17
    buffer_load_dwordx4 v36, s[16:19], s59 offen offset:0 lds
    buffer_load_dwordx4 v37, s[16:19], s59 offen offset:1024 lds
    s_waitcnt vmcnt(39)
    s_mov_b32 exec_hi, 0
    ds_write_b32 v14, v11
    s_mov_b32 exec_hi, -1
    s_waitcnt vmcnt(10)
    v_cmp_ne_u32 vcc, s48, v85
    v_cmp_ne_u32 s[52:53], s48, v87
    s_or_b64 vcc, vcc, s[52:53]
    s_cbranch_vccnz L_slow_st_50
L_back_st_51:
    v_mov_b32 v44, v84
    v_mov_b32 v45, v86
    s_mul_i32 s71, s61, 12288
    s_add_u32 s71, s71, 1048576
    s_mov_b32 s70, 0x07060302
    v_lshrrev_b32 v7, 3, v0
    v_mul_u32_u24 v7, 384, v7
    v_and_b32 v15, 7, v0
    v_lshl_add_u32 v7, v15, 4, v7
    v_lshlrev_b32 v15, 4, v0
    v_add_u32 v15, 98304, v15
    v_mov_b32 v100, 0
    v_mov_b32 v101, 0
    v_mov_b32 v102, 0
    v_mov_b32 v103, 0
    v_and_b32 v6, 31, v1
    v_min_u32 v6, 27, v6
    v_lshlrev_b32 v6, 4, v6
    s_mul_i32 s50, s3, 4576
    s_add_u32 s50, s50, 102400
    v_add_u32 v6, s50, v6
    buffer_load_dwordx4 v[48:51], v7, s[20:23], s71 offen offset:0 sc1
    buffer_load_dwordx4 v[52:55], v7, s[20:23], s71 offen offset:128 sc1
    buffer_load_dwordx4 v[56:59], v7, s[20:23], s71 offen offset:256 sc1
    ds_write_b128 v6, v[100:103]
    s_waitcnt vmcnt(0)
    v_xor_b32 v92, s48, v51
    v_bitop3_b32 v92, v55, s48, v92 bitop3:0xbe
    v_bitop3_b32 v92, v59, s48, v92 bitop3:0xbe
    v_cmp_ne_u32 vcc, 0, v92
    s_or_b32 s73, vcc_lo, vcc_hi
    v_mov_b32 v51, v56
    v_mov_b32 v55, v57
    ds_write_b128 v15, v[48:51] offset:4576
    v_alignbit_b32 v92, v49, v48, 16
    v_alignbit_b32 v93, v50, v49, 16
    v_alignbit_b32 v94, v51, v50, 16
    v_alignbit_b32 v95, v58, v51, 16
    ds_write_b128 v15, v[92:95] offset:0
    ds_write_b128 v15, v[52:55] offset:13728
    v_alignbit_b32 v96, v53, v52, 16
    v_alignbit_b32 v97, v54, v53, 16
    v_alignbit_b32 v98, v55, v54, 16
    v_perm_b32 v99, v58, v55, s70
    ds_write_b128 v15, v[96:99] offset:9152
    s_cmp_lg_u32 s73, 0
    s_cbranch_scc1 L_slow_u_54
L_back_u_55:
    s_waitcnt lgkmcnt(0)
    s_barrier
    s_cmp_lg_u32 s2, 255
    s_cbranch_scc1 L_gskip_58
    s_cmp_lg_u32 s3, 0
    s_cbranch_scc1 L_gskip_58
    s_mov_b32 s72, 1048588
    v_lshrrev_b32 v15, 3, v1
    v_mul_u32_u24 v15, 393216, v15
    v_and_b32 v92, 7, v1
    v_mul_u32_u24 v92, 1536, v92
    v_add_u32 v15, v15, v92
    buffer_load_dword v92, v15, s[20:23], s72 offen offset:0 sc1
    buffer_load_dword v93, v15, s[20:23], s72 offen offset:384 sc1
    buffer_load_dword v94, v15, s[20:23], s72 offen offset:768 sc1
    buffer_load_dword v95, v15, s[20:23], s72 offen offset:1152 sc1
L_gskip_58:
    ds_read_b128 a[112:115], v41 offset:3584
    ds_read_b128 a[116:119], v42 offset:0
    ds_read_b128 a[120:123], v41 offset:3072
    ds_read_b128 a[124:127], v42 offset:512
    ds_read_b128 a[128:131], v41 offset:2560
    ds_read_b128 a[132:135], v42 offset:1024
    ds_read_b128 a[136:139], v41 offset:2048
    ds_read_b128 a[140:143], v42 offset:1536
    ds_read_b128 a[144:147], v41 offset:1536
    ds_read_b128 a[148:151], v42 offset:2048
    ds_read_b128 a[152:155], v41 offset:1024
    ds_read_b128 a[156:159], v42 offset:2560
    ds_read_b128 a[160:163], v41 offset:512
    ds_read_b128 a[164:167], v42 offset:3072
    ds_read_b128 a[168:171], v41 offset:0
    ds_read_b128 a[172:175], v42 offset:3584
    s_add_u32 s50, s1, 0
    s_sub_u32 s51, s50, 7
    s_cselect_b32 s50, s50, s51
    s_lshl_b32 s50, s50, 13
    v_add_u32 v14, s50, v4
    s_add_u32 s50, s1, 1
    s_sub_u32 s51, s50, 7
    s_cselect_b32 s50, s50, s51
    s_lshl_b32 s50, s50, 13
    v_add_u32 v28, s50, v4
    s_add_u32 s50, s1, 2
    s_sub_u32 s51, s50, 7
    s_cselect_b32 s50, s50, s51
    s_lshl_b32 s50, s50, 13
    v_add_u32 v29, s50, v4
    s_add_u32 s50, s1, 3
    s_sub_u32 s51, s50, 7
    s_cselect_b32 s50, s50, s51
    s_lshl_b32 s50, s50, 13
    v_add_u32 v30, s50, v4
    s_add_u32 s50, s1, 4
    s_sub_u32 s51, s50, 7
    s_cselect_b32 s50, s50, s51
    s_lshl_b32 s50, s50, 13
    v_add_u32 v31, s50, v4
    s_add_u32 s50, s1, 5
    s_sub_u32 s51, s50, 7
    s_cselect_b32 s50, s50, s51
    s_lshl_b32 s50, s50, 13
    v_add_u32 v12, s50, v4
    s_add_u32 s50, s1, 6
    s_sub_u32 s51, s50, 7
    s_cselect_b32 s50, s50, s51
    s_lshl_b32 s50, s50, 13
    v_add_u32 v13, s50, v4
    s_waitcnt lgkmcnt(14)
    v_mfma_f32_16x16x32_bf16 v[96:99], a[112:115], a[116:119], 0
    s_mov_b32 s8, s20
    s_mov_b32 s9, s21
    s_waitcnt lgkmcnt(12)
    v_mfma_f32_16x16x32_bf16 v[100:103], a[112:115], a[124:127], 0
    v_mov_b32 v43, s48
    v_mfma_f32_16x16x32_bf16 v[100:103], a[120:123], a[116:119], v[100:103]
    v_mov_b32 v8, s48
    v_mfma_f32_16x16x32_bf16 v[104:107], a[120:123], a[124:127], 0
    ds_read_b128 a[176:179], v41 offset:3648
    s_waitcnt lgkmcnt(11)
    v_mfma_f32_16x16x32_bf16 v[104:107], a[112:115], a[132:135], v[104:107]
    s_add_u32 m0, s56, 32768
    s_add_u32 s59, s59, 16384
    buffer_load_dwordx4 v36, s[16:19], s59 offen offset:0 lds
    buffer_load_dwordx4 v37, s[16:19], s59 offen offset:1024 lds
    v_mfma_f32_16x16x32_bf16 v[104:107], a[128:131], a[116:119], v[104:107]
    ds_read_b128 a[180:183], v42 offset:64
    v_mfma_f32_16x16x32_bf16 v[108:111], a[120:123], a[132:135], 0
    v_mov_b32 v51, s48
    v_mfma_f32_16x16x32_bf16 v[108:111], a[128:131], a[124:127], v[108:111]
    ds_read_b128 a[184:187], v41 offset:3136
    v_mfma_f32_16x16x32_bf16 v[112:115], a[128:131], a[132:135], 0
    s_add_u32 m0, s56, 40960
    s_add_u32 s59, s1, 3
    s_sub_u32 s51, s59, 7
    s_cselect_b32 s59, s59, s51
    s_lshl_b32 s59, s59, 17
    buffer_load_dwordx4 v36, s[16:19], s59 offen offset:0 lds
    buffer_load_dwordx4 v37, s[16:19], s59 offen offset:1024 lds
    s_waitcnt lgkmcnt(11)
    v_mfma_f32_16x16x32_bf16 v[108:111], a[112:115], a[140:143], v[108:111]
    ds_read_b128 a[188:191], v42 offset:576
    v_mfma_f32_16x16x32_bf16 v[108:111], a[136:139], a[116:119], v[108:111]
    v_mov_b32 v55, s48
    v_mfma_f32_16x16x32_bf16 v[112:115], a[120:123], a[140:143], v[112:115]
    ds_read_b128 a[192:195], v41 offset:2624
    v_mfma_f32_16x16x32_bf16 v[112:115], a[136:139], a[124:127], v[112:115]
    s_add_u32 m0, s56, 49152
    s_add_u32 s59, s59, 16384
    buffer_load_dwordx4 v36, s[16:19], s59 offen offset:0 lds
    buffer_load_dwordx4 v37, s[16:19], s59 offen offset:1024 lds
    v_mfma_f32_16x16x32_bf16 v[116:119], a[128:131], a[140:143], 0
    ds_read_b128 a[196:199], v42 offset:1088
    v_mfma_f32_16x16x32_bf16 v[116:119], a[136:139], a[132:135], v[116:119]
    v_mov_b32 v58, s48
    v_mfma_f32_16x16x32_bf16 v[120:123], a[136:139], a[140:143], 0
    ds_read_b128 a[200:203], v41 offset:2112
    s_waitcnt lgkmcnt(13)
    v_mfma_f32_16x16x32_bf16 v[112:115], a[112:115], a[148:151], v[112:115]
    s_add_u32 m0, s56, 57344
    s_add_u32 s59, s1, 4
    s_sub_u32 s51, s59, 7
    s_cselect_b32 s59, s59, s51
    s_lshl_b32 s59, s59, 17
    buffer_load_dwordx4 v36, s[16:19], s59 offen offset:0 lds
    buffer_load_dwordx4 v37, s[16:19], s59 offen offset:1024 lds
    v_mfma_f32_16x16x32_bf16 v[112:115], a[144:147], a[116:119], v[112:115]
    ds_read_b128 a[204:207], v42 offset:1600
    v_mfma_f32_16x16x32_bf16 v[116:119], a[120:123], a[148:151], v[116:119]
    ds_read_b64_tr_b16 a[0:1], v38 offset:53248
    v_mfma_f32_16x16x32_bf16 v[116:119], a[144:147], a[124:127], v[116:119]
    ds_read_b128 a[208:211], v41 offset:1600
    v_mfma_f32_16x16x32_bf16 v[120:123], a[128:131], a[148:151], v[120:123]
    ds_read_b64_tr_b16 a[2:3], v38 offset:54272
    v_mfma_f32_16x16x32_bf16 v[120:123], a[144:147], a[132:135], v[120:123]
    ds_read_b128 a[212:215], v42 offset:2112
    v_mfma_f32_16x16x32_bf16 v[124:127], a[136:139], a[148:151], 0
    ds_read_b64_tr_b16 a[4:5], v39 offset:53248
    v_mfma_f32_16x16x32_bf16 v[124:127], a[144:147], a[140:143], v[124:127]
    ds_read_b128 a[224:227], v41 offset:1088
    s_waitcnt lgkmcnt(15)
    v_mfma_f32_16x16x32_bf16 v[116:119], a[112:115], a[156:159], v[116:119]
    ds_read_b64_tr_b16 a[6:7], v39 offset:54272
    v_mfma_f32_16x16x32_bf16 v[116:119], a[152:155], a[116:119], v[116:119]
    ds_read_b128 a[228:231], v42 offset:2624
    v_mfma_f32_16x16x32_bf16 v[120:123], a[120:123], a[156:159], v[120:123]
    ds_read_b64_tr_b16 a[8:9], v46 offset:0
    v_mfma_f32_16x16x32_bf16 v[120:123], a[152:155], a[124:127], v[120:123]
    ds_read_b128 a[232:235], v41 offset:576
    v_mfma_f32_16x16x32_bf16 v[124:127], a[128:131], a[156:159], v[124:127]
    ds_read_b64_tr_b16 a[10:11], v46 offset:1024
    v_mfma_f32_16x16x32_bf16 v[124:127], a[152:155], a[132:135], v[124:127]
    ds_read_b128 a[236:239], v42 offset:3136
    v_mfma_f32_16x16x32_bf16 v[120:123], a[112:115], a[164:167], v[120:123]
    ds_read_b64_tr_b16 a[12:13], v47 offset:0
    v_mfma_f32_16x16x32_bf16 v[120:123], a[160:163], a[116:119], v[120:123]
    ds_read_b128 a[240:243], v41 offset:64
    v_mfma_f32_16x16x32_bf16 v[124:127], a[120:123], a[164:167], v[124:127]
    ds_read_b64_tr_b16 a[14:15], v47 offset:1024
    v_mfma_f32_16x16x32_bf16 v[124:127], a[160:163], a[124:127], v[124:127]
    ds_read_b128 a[244:247], v42 offset:3648
    s_waitcnt lgkmcnt(15)
    v_mfma_f32_16x16x32_bf16 v[124:127], a[112:115], a[172:175], v[124:127]
    s_waitcnt lgkmcnt(1)
    s_add_u32 m0, s56, 0
    s_add_u32 s59, s59, 16384
    buffer_load_dwordx4 v36, s[16:19], s59 offen offset:0 lds
    buffer_load_dwordx4 v37, s[16:19], s59 offen offset:1024 lds
    v_mfma_f32_16x16x32_bf16 v[124:127], a[168:171], a[116:119], v[124:127]
    ds_read_b64_tr_b16 a[16:17], v46 offset:8192
    v_mfma_f32_16x16x32_bf16 v[96:99], a[112:115], a[108:111], v[96:99]
    ds_read_b64_tr_b16 a[18:19], v46 offset:9216
    ds_read_b64_tr_b16 a[20:21], v47 offset:8192
    ds_read_b64_tr_b16 a[22:23], v47 offset:9216
    ds_read_b64_tr_b16 a[24:25], v46 offset:16384
    v_mfma_f32_16x16x32_bf16 v[100:103], a[120:123], a[108:111], v[100:103]
    ds_read_b64_tr_b16 a[26:27], v46 offset:17408
    ds_read_b64_tr_b16 a[28:29], v47 offset:16384
    ds_read_b64_tr_b16 a[30:31], v47 offset:17408
    ds_read_b64_tr_b16 a[32:33], v46 offset:24576
    v_mfma_f32_16x16x32_bf16 v[104:107], a[128:131], a[108:111], v[104:107]
    s_waitcnt lgkmcnt(5)
    s_add_u32 m0, s56, 8192
    s_add_u32 s59, s1, 5
    s_sub_u32 s51, s59, 7
    s_cselect_b32 s59, s59, s51
    s_lshl_b32 s59, s59, 17
    buffer_load_dwordx4 v36, s[16:19], s59 offen offset:0 lds
    buffer_load_dwordx4 v37, s[16:19], s59 offen offset:1024 lds
    v_mfma_f32_16x16x32_bf16 v[108:111], a[136:139], a[108:111], v[108:111]
    ds_read_b64_tr_b16 a[34:35], v46 offset:25600
    ds_read_b64_tr_b16 a[36:37], v47 offset:24576
    ds_read_b64_tr_b16 a[38:39], v47 offset:25600
    s_waitcnt vmcnt(10)
    ds_read_b64_tr_b16 a[40:41], v46 offset:32768
    v_mfma_f32_16x16x32_bf16 v[112:115], a[144:147], a[108:111], v[112:115]
    ds_read_b64_tr_b16 a[42:43], v46 offset:33792
    ds_read_b64_tr_b16 a[44:45], v47 offset:32768
    ds_read_b64_tr_b16 a[46:47], v47 offset:33792
    s_waitcnt vmcnt(8)
    ds_read_b64_tr_b16 a[48:49], v46 offset:40960
    v_mfma_f32_16x16x32_bf16 v[116:119], a[152:155], a[108:111], v[116:119]
    s_waitcnt lgkmcnt(9)
    s_add_u32 m0, s56, 16384
    s_add_u32 s59, s59, 16384
    buffer_load_dwordx4 v36, s[16:19], s59 offen offset:0 lds
    buffer_load_dwordx4 v37, s[16:19], s59 offen offset:1024 lds
    v_mfma_f32_16x16x32_bf16 v[120:123], a[160:163], a[108:111], v[120:123]
    ds_read_b64_tr_b16 a[50:51], v46 offset:41984
    ds_read_b64_tr_b16 a[52:53], v47 offset:40960
    ds_read_b64_tr_b16 a[54:55], v47 offset:41984
    s_waitcnt vmcnt(8)
    ds_read_b64_tr_b16 a[56:57], v46 offset:49152
    v_mfma_f32_16x16x32_bf16 v[124:127], a[168:171], a[108:111], v[124:127]
    ds_read_b64_tr_b16 a[58:59], v46 offset:50176
    ds_read_b64_tr_b16 a[60:61], v47 offset:49152
    ds_read_b64_tr_b16 a[62:63], v47 offset:50176
    s_waitcnt vmcnt(6)
    ds_read_b64_tr_b16 a[64:65], v46 offset:57344
    v_mfma_f32_16x16x32_bf16 v[96:99], a[176:179], a[180:183], v[96:99]
    ds_read_b64_tr_b16 a[66:67], v46 offset:58368
    v_mfma_f32_16x16x32_bf16 v[100:103], a[176:179], a[188:191], v[100:103]
    s_waitcnt lgkmcnt(14)
    s_add_u32 m0, s56, 24576
    s_add_u32 s59, s1, 6
    s_sub_u32 s51, s59, 7
    s_cselect_b32 s59, s59, s51
    s_lshl_b32 s59, s59, 17
    buffer_load_dwordx4 v36, s[16:19], s59 offen offset:0 lds
    buffer_load_dwordx4 v37, s[16:19], s59 offen offset:1024 lds
    v_mfma_f32_16x16x32_bf16 v[100:103], a[184:187], a[180:183], v[100:103]
    ds_read_b64_tr_b16 a[68:69], v47 offset:57344
    v_mfma_f32_16x16x32_bf16 v[104:107], a[184:187], a[188:191], v[104:107]
    ds_read_b128 a[112:115], v41 offset:3712
    v_mfma_f32_16x16x32_bf16 v[104:107], a[176:179], a[196:199], v[104:107]
    ds_read_b64_tr_b16 a[70:71], v47 offset:58368
    v_mfma_f32_16x16x32_bf16 v[104:107], a[192:195], a[180:183], v[104:107]
    ds_read_b128 a[116:119], v42 offset:128
    v_mfma_f32_16x16x32_bf16 v[108:111], a[184:187], a[196:199], v[108:111]
    s_waitcnt lgkmcnt(14)
    s_add_u32 m0, s56, 32768
    s_add_u32 s59, s59, 16384
    buffer_load_dwordx4 v36, s[16:19], s59 offen offset:0 lds
    buffer_load_dwordx4 v37, s[16:19], s59 offen offset:1024 lds
    v_mfma_f32_16x16x32_bf16 v[108:111], a[192:195], a[188:191], v[108:111]
    ds_read_b128 a[120:123], v41 offset:3200
    v_mfma_f32_16x16x32_bf16 v[112:115], a[192:195], a[196:199], v[112:115]
    s_mov_b64 exec, 0x7f
    buffer_load_dword v43, v5, s[20:23], s27 offen sc1
    s_mov_b64 exec, -1
    v_mfma_f32_16x16x32_bf16 v[108:111], a[176:179], a[204:207], v[108:111]
    ds_read_b128 a[124:127], v42 offset:640
    v_mfma_f32_16x16x32_bf16 v[108:111], a[200:203], a[180:183], v[108:111]
    s_waitcnt vmcnt(9)
    ds_read_b64_tr_b16 a[72:73], v46 offset:0
    v_mfma_f32_16x16x32_bf16 v[112:115], a[184:187], a[204:207], v[112:115]
    ds_read_b128 a[128:131], v41 offset:2688
    v_mfma_f32_16x16x32_bf16 v[112:115], a[200:203], a[188:191], v[112:115]
    ds_read_b64_tr_b16 a[74:75], v46 offset:1024
    v_mfma_f32_16x16x32_bf16 v[116:119], a[192:195], a[204:207], v[116:119]
    ds_read_b128 a[132:135], v42 offset:1152
    v_mfma_f32_16x16x32_bf16 v[116:119], a[200:203], a[196:199], v[116:119]
    ds_read_b64_tr_b16 a[76:77], v47 offset:0
    v_mfma_f32_16x16x32_bf16 v[120:123], a[200:203], a[204:207], v[120:123]
    ds_read_b128 a[136:139], v41 offset:2176
    v_mfma_f32_16x16x32_bf16 v[112:115], a[176:179], a[212:215], v[112:115]
    ds_read_b64_tr_b16 a[78:79], v47 offset:1024
    v_mfma_f32_16x16x32_bf16 v[112:115], a[208:211], a[180:183], v[112:115]
    ds_read_b128 a[140:143], v42 offset:1664
    v_mfma_f32_16x16x32_bf16 v[116:119], a[184:187], a[212:215], v[116:119]
    s_waitcnt vmcnt(7)
    ds_read_b64_tr_b16 a[80:81], v46 offset:8192
    v_mfma_f32_16x16x32_bf16 v[116:119], a[208:211], a[188:191], v[116:119]
    ds_read_b128 a[144:147], v41 offset:1664
    v_mfma_f32_16x16x32_bf16 v[120:123], a[192:195], a[212:215], v[120:123]
    ds_read_b64_tr_b16 a[82:83], v46 offset:9216
    v_mfma_f32_16x16x32_bf16 v[120:123], a[208:211], a[196:199], v[120:123]
    ds_read_b128 a[148:151], v42 offset:2176
    v_mfma_f32_16x16x32_bf16 v[124:127], a[200:203], a[212:215], v[124:127]
    ds_read_b64_tr_b16 a[84:85], v47 offset:8192
    v_mfma_f32_16x16x32_bf16 v[124:127], a[208:211], a[204:207], v[124:127]
    ds_read_b128 a[152:155], v41 offset:1152
    v_mfma_f32_16x16x32_bf16 v[116:119], a[176:179], a[228:231], v[116:119]
    ds_read_b64_tr_b16 a[86:87], v47 offset:9216
    v_mfma_f32_16x16x32_bf16 v[116:119], a[224:227], a[180:183], v[116:119]
    ds_read_b128 a[156:159], v42 offset:2688
    v_mfma_f32_16x16x32_bf16 v[120:123], a[184:187], a[228:231], v[120:123]
    s_waitcnt vmcnt(5)
    ds_read_b64_tr_b16 a[88:89], v46 offset:16384
    v_mfma_f32_16x16x32_bf16 v[120:123], a[224:227], a[188:191], v[120:123]
    ds_read_b128 a[160:163], v41 offset:640
    v_mfma_f32_16x16x32_bf16 v[124:127], a[192:195], a[228:231], v[124:127]
    ds_read_b64_tr_b16 a[90:91], v46 offset:17408
    v_mfma_f32_16x16x32_bf16 v[124:127], a[224:227], a[196:199], v[124:127]
    ds_read_b128 a[164:167], v42 offset:3200
    v_mfma_f32_16x16x32_bf16 v[120:123], a[176:179], a[236:239], v[120:123]
    s_waitcnt vmcnt(0)
    v_cmp_ne_u32 vcc, s48, v43
    s_or_b32 s75, vcc_lo, vcc_hi
    s_cselect_b32 s10, 0, 33554432
    v_mfma_f32_16x16x32_bf16 v[120:123], a[232:235], a[180:183], v[120:123]
    ds_read_b128 a[168:171], v41 offset:128
    v_mfma_f32_16x16x32_bf16 v[124:127], a[184:187], a[236:239], v[124:127]
    s_cmp_lg_u32 s75, 0
    s_cbranch_scc1 L_slow_h2_59
L_back_h2_60:
    buffer_load_dwordx4 v[192:195], v14, s[8:11], s28 offen offset:0 sc1
    v_mfma_f32_16x16x32_bf16 v[124:127], a[232:235], a[188:191], v[124:127]
    ds_read_b128 a[172:175], v42 offset:3712
    v_mfma_f32_16x16x32_bf16 v[124:127], a[176:179], a[244:247], v[124:127]
    ds_read_b64_tr_b16 a[92:93], v47 offset:16384
    v_mfma_f32_16x16x32_bf16 v[124:127], a[240:243], a[180:183], v[124:127]
    ds_read_b64_tr_b16 a[94:95], v47 offset:17408
    s_waitcnt lgkmcnt(15)
    v_mfma_f32_16x16x32_bf16 v[96:99], a[112:115], a[116:119], v[96:99]
    buffer_load_dwordx4 v[196:199], v14, s[8:11], s28 offen offset:1024 sc1
    v_mfma_f32_16x16x32_bf16 v[100:103], a[112:115], a[124:127], v[100:103]
    ds_read_b64_tr_b16 a[96:97], v46 offset:24576
    v_mfma_f32_16x16x32_bf16 v[100:103], a[120:123], a[116:119], v[100:103]
    ds_read_b64_tr_b16 a[98:99], v46 offset:25600
    v_mfma_f32_16x16x32_bf16 v[104:107], a[120:123], a[124:127], v[104:107]
    ds_read_b128 a[176:179], v41 offset:3776
    v_mfma_f32_16x16x32_bf16 v[104:107], a[112:115], a[132:135], v[104:107]
    buffer_load_dwordx4 v[200:203], v28, s[8:11], s28 offen offset:0 sc1
    v_mfma_f32_16x16x32_bf16 v[104:107], a[128:131], a[116:119], v[104:107]
    ds_read_b128 a[180:183], v42 offset:192
    v_mfma_f32_16x16x32_bf16 v[108:111], a[120:123], a[132:135], v[108:111]
    ds_read_b64_tr_b16 a[100:101], v47 offset:24576
    v_mfma_f32_16x16x32_bf16 v[108:111], a[128:131], a[124:127], v[108:111]
    ds_read_b128 a[184:187], v41 offset:3264
    v_mfma_f32_16x16x32_bf16 v[112:115], a[128:131], a[132:135], v[112:115]
    buffer_load_dwordx4 v[204:207], v28, s[8:11], s28 offen offset:1024 sc1
    v_mfma_f32_16x16x32_bf16 v[108:111], a[112:115], a[140:143], v[108:111]
    ds_read_b128 a[188:191], v42 offset:704
    v_mfma_f32_16x16x32_bf16 v[108:111], a[136:139], a[116:119], v[108:111]
    ds_read_b64_tr_b16 a[102:103], v47 offset:25600
    v_mfma_f32_16x16x32_bf16 v[112:115], a[120:123], a[140:143], v[112:115]
    ds_read_b128 a[192:195], v41 offset:2752
    v_mfma_f32_16x16x32_bf16 v[112:115], a[136:139], a[124:127], v[112:115]
    buffer_load_dwordx4 v[208:211], v29, s[8:11], s28 offen offset:0 sc1
    v_mfma_f32_16x16x32_bf16 v[116:119], a[128:131], a[140:143], v[116:119]
    ds_read_b128 a[196:199], v42 offset:1216
    v_mfma_f32_16x16x32_bf16 v[116:119], a[136:139], a[132:135], v[116:119]
    ds_read_b64_tr_b16 a[104:105], v46 offset:32768
    v_mfma_f32_16x16x32_bf16 v[120:123], a[136:139], a[140:143], v[120:123]
    ds_read_b128 a[200:203], v41 offset:2240
    s_waitcnt lgkmcnt(15)
    v_mfma_f32_16x16x32_bf16 v[112:115], a[112:115], a[148:151], v[112:115]
    buffer_load_dwordx4 v[212:215], v29, s[8:11], s28 offen offset:1024 sc1
    v_mfma_f32_16x16x32_bf16 v[112:115], a[144:147], a[116:119], v[112:115]
    ds_read_b128 a[204:207], v42 offset:1728
    v_mfma_f32_16x16x32_bf16 v[116:119], a[120:123], a[148:151], v[116:119]
    ds_read_b64_tr_b16 a[106:107], v46 offset:33792
    v_mfma_f32_16x16x32_bf16 v[116:119], a[144:147], a[124:127], v[116:119]
    ds_read_b128 a[208:211], v41 offset:1728
    v_mfma_f32_16x16x32_bf16 v[120:123], a[128:131], a[148:151], v[120:123]
    s_cmp_lg_u32 s75, 0
    s_cbranch_scc1 L_slow_h2_63
L_back_h2_64:
    buffer_load_dwordx4 v[216:219], v30, s[8:11], s28 offen offset:0 sc1
    v_mfma_f32_16x16x32_bf16 v[120:123], a[144:147], a[132:135], v[120:123]
    ds_read_b128 a[212:215], v42 offset:2240
    v_mfma_f32_16x16x32_bf16 v[124:127], a[136:139], a[148:151], v[124:127]
    ds_read_b64_tr_b16 a[108:109], v47 offset:32768
    v_mfma_f32_16x16x32_bf16 v[124:127], a[144:147], a[140:143], v[124:127]
    ds_read_b128 a[224:227], v41 offset:1216
    v_mfma_f32_16x16x32_bf16 v[116:119], a[112:115], a[156:159], v[116:119]
    buffer_load_dwordx4 v[220:223], v30, s[8:11], s28 offen offset:1024 sc1
    v_mfma_f32_16x16x32_bf16 v[116:119], a[152:155], a[116:119], v[116:119]
    ds_read_b128 a[228:231], v42 offset:2752
    v_mfma_f32_16x16x32_bf16 v[120:123], a[120:123], a[156:159], v[120:123]
    ds_read_b64_tr_b16 a[110:111], v47 offset:33792
    v_mfma_f32_16x16x32_bf16 v[120:123], a[152:155], a[124:127], v[120:123]
    ds_read_b128 a[232:235], v41 offset:704
    v_mfma_f32_16x16x32_bf16 v[124:127], a[128:131], a[156:159], v[124:127]
    buffer_load_dwordx4 v[224:227], v31, s[8:11], s28 offen offset:0 sc1
    v_mfma_f32_16x16x32_bf16 v[124:127], a[152:155], a[132:135], v[124:127]
    ds_read_b128 a[236:239], v42 offset:3264
    v_mfma_f32_16x16x32_bf16 v[120:123], a[112:115], a[164:167], v[120:123]
    v_mov_b32 v59, s48
    v_mfma_f32_16x16x32_bf16 v[120:123], a[160:163], a[116:119], v[120:123]
    ds_read_b128 a[240:243], v41 offset:192
    v_mfma_f32_16x16x32_bf16 v[124:127], a[120:123], a[164:167], v[124:127]
    buffer_load_dwordx4 v[228:231], v31, s[8:11], s28 offen offset:1024 sc1
    v_mfma_f32_16x16x32_bf16 v[124:127], a[160:163], a[124:127], v[124:127]
    ds_read_b128 a[244:247], v42 offset:3776
    s_waitcnt lgkmcnt(15)
    v_mfma_f32_16x16x32_bf16 v[124:127], a[112:115], a[172:175], v[124:127]
    v_mfma_f32_16x16x32_bf16 v[124:127], a[168:171], a[116:119], v[124:127]
    v_mfma_f32_16x16x32_bf16 v[96:99], a[176:179], a[180:183], v[96:99]
    buffer_load_dwordx4 v[232:235], v12, s[8:11], s28 offen offset:0 sc1
    v_mfma_f32_16x16x32_bf16 v[100:103], a[176:179], a[188:191], v[100:103]
    v_mfma_f32_16x16x32_bf16 v[100:103], a[184:187], a[180:183], v[100:103]
    v_mfma_f32_16x16x32_bf16 v[104:107], a[184:187], a[188:191], v[104:107]
    s_waitcnt lgkmcnt(14)
    v_mfma_f32_16x16x32_bf16 v[104:107], a[176:179], a[196:199], v[104:107]
    buffer_load_dwordx4 v[236:239], v12, s[8:11], s28 offen offset:1024 sc1
    v_mfma_f32_16x16x32_bf16 v[104:107], a[192:195], a[180:183], v[104:107]
    v_mfma_f32_16x16x32_bf16 v[108:111], a[184:187], a[196:199], v[108:111]
    v_mfma_f32_16x16x32_bf16 v[108:111], a[192:195], a[188:191], v[108:111]
    v_mfma_f32_16x16x32_bf16 v[112:115], a[192:195], a[196:199], v[112:115]
    s_cmp_lg_u32 s75, 0
    s_cbranch_scc1 L_slow_h2_67
L_back_h2_68:
    buffer_load_dwordx4 v[240:243], v13, s[8:11], s28 offen offset:0 sc1
    s_waitcnt lgkmcnt(11)
    v_mfma_f32_16x16x32_bf16 v[108:111], a[176:179], a[204:207], v[108:111]
    v_mfma_f32_16x16x32_bf16 v[108:111], a[200:203], a[180:183], v[108:111]
    v_mfma_f32_16x16x32_bf16 v[112:115], a[184:187], a[204:207], v[112:115]
    v_mfma_f32_16x16x32_bf16 v[112:115], a[200:203], a[188:191], v[112:115]
    buffer_load_dwordx4 v[244:247], v13, s[8:11], s28 offen offset:1024 sc1
    v_mfma_f32_16x16x32_bf16 v[116:119], a[192:195], a[204:207], v[116:119]
    v_mfma_f32_16x16x32_bf16 v[116:119], a[200:203], a[196:199], v[116:119]
    v_mfma_f32_16x16x32_bf16 v[120:123], a[200:203], a[204:207], v[120:123]
    s_waitcnt lgkmcnt(8)
    v_mfma_f32_16x16x32_bf16 v[112:115], a[176:179], a[212:215], v[112:115]
    buffer_load_dwordx4 v[248:251], v14, s[8:11], s29 offen offset:0 sc1
    v_mfma_f32_16x16x32_bf16 v[112:115], a[208:211], a[180:183], v[112:115]
    v_mfma_f32_16x16x32_bf16 v[116:119], a[184:187], a[212:215], v[116:119]
    v_mfma_f32_16x16x32_bf16 v[116:119], a[208:211], a[188:191], v[116:119]
    v_mfma_f32_16x16x32_bf16 v[120:123], a[192:195], a[212:215], v[120:123]
    buffer_load_dwordx4 v[252:255], v14, s[8:11], s29 offen offset:1024 sc1
    v_mfma_f32_16x16x32_bf16 v[120:123], a[208:211], a[196:199], v[120:123]
    v_mfma_f32_16x16x32_bf16 v[124:127], a[200:203], a[212:215], v[124:127]
    v_mfma_f32_16x16x32_bf16 v[124:127], a[208:211], a[204:207], v[124:127]
    s_waitcnt lgkmcnt(5)
    v_mfma_f32_16x16x32_bf16 v[116:119], a[176:179], a[228:231], v[116:119]
    buffer_load_dwordx4 a[248:251], v28, s[8:11], s29 offen offset:0 sc1
    v_mfma_f32_16x16x32_bf16 v[116:119], a[224:227], a[180:183], v[116:119]
    v_mfma_f32_16x16x32_bf16 v[120:123], a[184:187], a[228:231], v[120:123]
    v_mfma_f32_16x16x32_bf16 v[120:123], a[224:227], a[188:191], v[120:123]
    v_mfma_f32_16x16x32_bf16 v[124:127], a[192:195], a[228:231], v[124:127]
    buffer_load_dwordx4 a[252:255], v28, s[8:11], s29 offen offset:1024 sc1
    v_mfma_f32_16x16x32_bf16 v[124:127], a[224:227], a[196:199], v[124:127]
    s_waitcnt lgkmcnt(2)
    v_mfma_f32_16x16x32_bf16 v[120:123], a[176:179], a[236:239], v[120:123]
    v_mfma_f32_16x16x32_bf16 v[120:123], a[232:235], a[180:183], v[120:123]
    v_mfma_f32_16x16x32_bf16 v[124:127], a[184:187], a[236:239], v[124:127]
    s_cmp_lg_u32 s75, 0
    s_cbranch_scc1 L_slow_h2_71
L_back_h2_72:
    buffer_load_dwordx4 a[112:115], v29, s[8:11], s29 offen offset:0 sc1
    v_mfma_f32_16x16x32_bf16 v[124:127], a[232:235], a[188:191], v[124:127]
    s_waitcnt lgkmcnt(0)
    v_mfma_f32_16x16x32_bf16 v[124:127], a[176:179], a[244:247], v[124:127]
    v_mfma_f32_16x16x32_bf16 v[124:127], a[240:243], a[180:183], v[124:127]
    s_cmp_lg_u32 s2, 255
    s_cbranch_scc1 L_gskip_75
    s_cmp_lg_u32 s3, 0
    s_cbranch_scc1 L_gskip_75
    v_cmp_ne_u32 vcc, s48, v92
    v_cmp_ne_u32 s[52:53], s48, v93
    s_or_b64 vcc, vcc, s[52:53]
    v_cmp_ne_u32 s[52:53], s48, v94
    s_or_b64 vcc, vcc, s[52:53]
    v_cmp_ne_u32 s[52:53], s48, v95
    s_or_b64 vcc, vcc, s[52:53]
    s_cbranch_vccnz L_slow_gen_76
L_back_gen_77:
    s_mov_b32 s72, 0
    buffer_store_dword v3, v2, s[20:23], s72 offen sc1
L_gskip_75:
    s_cmp_lg_u32 s75, 0
    s_cbranch_scc1 L_slow_h_80
L_back_h_81:
    s_waitcnt vmcnt(18)
    v_mfma_f32_32x32x16_bf16 v[144:159], a[4:7], v[192:195], 0
    buffer_load_dwordx4 a[116:119], v29, s[8:11], s29 offen offset:1024 sc1
    v_mfma_f32_32x32x16_bf16 v[128:143], a[0:3], v[192:195], 0
    s_waitcnt vmcnt(18)
    v_mfma_f32_32x32x16_bf16 v[144:159], a[12:15], v[196:199], v[144:159]
    buffer_load_dwordx4 a[120:123], v30, s[8:11], s29 offen offset:0 sc1
    ds_write2_b64 v21, v[96:97], v[98:99] offset0:0 offset1:16
    v_mfma_f32_32x32x16_bf16 v[128:143], a[8:11], v[196:199], v[128:143]
    ds_write2_b64 v21, v[100:101], v[102:103] offset0:128 offset1:144
    s_waitcnt vmcnt(18)
    v_mfma_f32_32x32x16_bf16 v[144:159], a[20:23], v[200:203], v[144:159]
    s_add_u32 s66, s27, 0x20000
    s_mov_b64 exec, 0x7f
    buffer_load_dword v8, v5, s[20:23], s66 offen sc1
    s_mov_b64 exec, -1
    buffer_load_dwordx4 a[124:127], v30, s[8:11], s29 offen offset:1024 sc1
    v_mfma_f32_32x32x16_bf16 v[128:143], a[16:19], v[200:203], v[128:143]
    v_add_u32 v21, 0x800, v21
    ds_write2_b64 v21, v[104:105], v[106:107] offset0:0 offset1:16
    s_waitcnt vmcnt(19)
    v_mfma_f32_32x32x16_bf16 v[144:159], a[28:31], v[204:207], v[144:159]
    buffer_load_dwordx4 a[128:131], v31, s[8:11], s29 offen offset:0 sc1
    ds_write2_b64 v21, v[108:109], v[110:111] offset0:128 offset1:144
    v_mfma_f32_32x32x16_bf16 v[128:143], a[24:27], v[204:207], v[128:143]
    v_add_u32 v21, 0x800, v21
    ds_write2_b64 v21, v[112:113], v[114:115] offset0:0 offset1:16
    s_waitcnt vmcnt(19)
    v_mfma_f32_32x32x16_bf16 v[144:159], a[36:39], v[208:211], v[144:159]
    buffer_load_dwordx4 a[132:135], v31, s[8:11], s29 offen offset:1024 sc1
    ds_write2_b64 v21, v[116:117], v[118:119] offset0:128 offset1:144
    v_mfma_f32_32x32x16_bf16 v[128:143], a[32:35], v[208:211], v[128:143]
    v_add_u32 v21, 0x800, v21
    ds_write2_b64 v21, v[120:121], v[122:123] offset0:0 offset1:16
    s_waitcnt vmcnt(19)
    v_mfma_f32_32x32x16_bf16 v[144:159], a[44:47], v[212:215], v[144:159]
    buffer_load_dwordx4 a[136:139], v12, s[8:11], s29 offen offset:0 sc1
    ds_write2_b64 v21, v[124:125], v[126:127] offset0:128 offset1:144
    v_mfma_f32_32x32x16_bf16 v[128:143], a[40:43], v[212:215], v[128:143]
    s_waitcnt vmcnt(19)
    v_mfma_f32_32x32x16_bf16 v[144:159], a[52:55], v[216:219], v[144:159]
    buffer_load_dwordx4 a[140:143], v12, s[8:11], s29 offen offset:1024 sc1
    v_mfma_f32_32x32x16_bf16 v[128:143], a[48:51], v[216:219], v[128:143]
    s_waitcnt vmcnt(19)
    v_mfma_f32_32x32x16_bf16 v[144:159], a[60:63], v[220:223], v[144:159]
    buffer_load_dwordx4 a[144:147], v13, s[8:11], s29 offen offset:0 sc1
    v_mfma_f32_32x32x16_bf16 v[128:143], a[56:59], v[220:223], v[128:143]
    s_waitcnt lgkmcnt(0)
    s_barrier
    ds_read_b128 v[96:99], v22 offset:0
    ds_read_b128 v[100:103], v22 offset:16
    ds_read_b128 v[104:107], v22 offset:8192
    s_waitcnt vmcnt(19)
    v_mfma_f32_32x32x16_bf16 v[144:159], a[68:71], v[224:227], v[144:159]
    buffer_load_dwordx4 a[148:151], v13, s[8:11], s29 offen offset:1024 sc1
    ds_read_b128 v[108:111], v22 offset:8208
    ds_read_b128 v[112:115], v22 offset:16384
    v_mfma_f32_32x32x16_bf16 v[128:143], a[64:67], v[224:227], v[128:143]
    ds_read_b128 v[116:119], v22 offset:16400
    ds_read_b128 v[120:123], v22 offset:24576
    ds_read_b128 v[124:127], v22 offset:24592
    s_waitcnt vmcnt(19)
    v_mfma_f32_32x32x16_bf16 v[144:159], a[76:79], v[228:231], v[144:159]
    s_waitcnt vmcnt(7)
    v_cmp_ne_u32 vcc, s48, v8
    s_cbranch_vccnz L_slow_hb_84
L_back_hb_85:
    buffer_load_dwordx4 a[152:155], v14, s[8:11], s30 offen offset:0 sc1
    v_mfma_f32_32x32x16_bf16 v[128:143], a[72:75], v[228:231], v[128:143]
    s_waitcnt lgkmcnt(4)
    v_add_f32 v96, v96, v104
    v_add_f32 v97, v97, v105
    v_add_f32 v98, v98, v106
    v_add_f32 v99, v99, v107
    v_mfma_f32_32x32x16_bf16 v[144:159], a[84:87], v[232:235], v[144:159]
    buffer_load_dwordx4 a[156:159], v14, s[8:11], s30 offen offset:1024 sc1
    v_add_f32 v100, v100, v108
    v_add_f32 v101, v101, v109
    v_mfma_f32_32x32x16_bf16 v[128:143], a[80:83], v[232:235], v[128:143]
    v_add_f32 v102, v102, v110
    v_add_f32 v103, v103, v111
    v_cvt_pk_bf16_f32 v48, v96, v97
    v_cvt_pk_bf16_f32 v49, v98, v99
    v_cvt_pk_bf16_f32 v50, v100, v101
    v_mfma_f32_32x32x16_bf16 v[144:159], a[92:95], v[236:239], v[144:159]
    buffer_load_dwordx4 a[160:163], v28, s[8:11], s30 offen offset:0 sc1
    v_cvt_pk_bf16_f32 v56, v102, v103
    s_waitcnt lgkmcnt(0)
    v_add_f32 v112, v112, v120
    v_mfma_f32_32x32x16_bf16 v[128:143], a[88:91], v[236:239], v[128:143]
    v_add_f32 v113, v113, v121
    v_add_f32 v114, v114, v122
    v_add_f32 v115, v115, v123
    v_add_f32 v116, v116, v124
    v_add_f32 v117, v117, v125
    v_mfma_f32_32x32x16_bf16 v[144:159], a[100:103], v[240:243], v[144:159]
    buffer_load_dwordx4 a[164:167], v28, s[8:11], s30 offen offset:1024 sc1
    v_add_f32 v118, v118, v126
    v_add_f32 v119, v119, v127
    v_mfma_f32_32x32x16_bf16 v[128:143], a[96:99], v[240:243], v[128:143]
    v_cvt_pk_bf16_f32 v52, v112, v113
    v_cvt_pk_bf16_f32 v53, v114, v115
    v_cvt_pk_bf16_f32 v54, v116, v117
    v_cvt_pk_bf16_f32 v57, v118, v119
    buffer_store_dwordx4 v[48:51], v23, s[20:23], s40 offen offset:0 sc1
    buffer_store_dwordx4 v[52:55], v23, s[20:23], s40 offen offset:128 sc1
    buffer_store_dwordx4 v[56:59], v23, s[20:23], s40 offen offset:256 sc1
    v_mfma_f32_32x32x16_bf16 v[144:159], a[108:111], v[244:247], v[144:159]
    buffer_load_dwordx4 a[168:171], v29, s[8:11], s30 offen offset:0 sc1
    v_mfma_f32_32x32x16_bf16 v[128:143], a[104:107], v[244:247], v[128:143]
    v_mfma_f32_32x32x16_bf16 v[176:191], a[4:7], v[248:251], 0
    buffer_load_dwordx4 a[172:175], v29, s[8:11], s30 offen offset:1024 sc1
    v_mfma_f32_32x32x16_bf16 v[160:175], a[0:3], v[248:251], 0
    s_nop 8
    ds_write_b128 v33, v[128:131] offset:0
    v_mfma_f32_32x32x16_bf16 v[176:191], a[12:15], v[252:255], v[176:191]
    buffer_load_dwordx4 a[176:179], v30, s[8:11], s30 offen offset:0 sc1
    ds_write_b128 v33, v[132:135] offset:1024
    v_mfma_f32_32x32x16_bf16 v[160:175], a[8:11], v[252:255], v[160:175]
    ds_write_b128 v33, v[136:139] offset:2048
    v_mfma_f32_32x32x16_bf16 v[176:191], a[20:23], a[248:251], v[176:191]
    buffer_load_dwordx4 a[180:183], v30, s[8:11], s30 offen offset:1024 sc1
    ds_write_b128 v33, v[140:143] offset:3072
    v_mfma_f32_32x32x16_bf16 v[160:175], a[16:19], a[248:251], v[160:175]
    ds_write_b128 v34, v[144:147] offset:0
    v_accvgpr_read_b32 v97, a216
    v_lshlrev_b32 v96, 16, v97
    v_and_b32 v97, s49, v97
    v_mfma_f32_32x32x16_bf16 v[176:191], a[28:31], a[252:255], v[176:191]
    buffer_load_dwordx4 a[184:187], v31, s[8:11], s30 offen offset:0 sc1
    ds_write_b128 v34, v[148:151] offset:1024
    v_mfma_f32_32x32x16_bf16 v[160:175], a[24:27], a[252:255], v[160:175]
    ds_write_b128 v34, v[152:155] offset:2048
    v_accvgpr_read_b32 v99, a217
    v_lshlrev_b32 v98, 16, v99
    v_and_b32 v99, s49, v99
    v_mfma_f32_32x32x16_bf16 v[176:191], a[36:39], a[112:115], v[176:191]
    buffer_load_dwordx4 a[188:191], v31, s[8:11], s30 offen offset:1024 sc1
    ds_write_b128 v34, v[156:159] offset:3072
    v_mfma_f32_32x32x16_bf16 v[160:175], a[32:35], a[112:115], v[160:175]
    v_accvgpr_read_b32 v101, a218
    v_lshlrev_b32 v100, 16, v101
    v_and_b32 v101, s49, v101
    v_accvgpr_read_b32 v103, a219
    v_lshlrev_b32 v102, 16, v103
    v_mfma_f32_32x32x16_bf16 v[176:191], a[44:47], a[116:119], v[176:191]
    buffer_load_dwordx4 a[192:195], v12, s[8:11], s30 offen offset:0 sc1
    v_and_b32 v103, s49, v103
    v_accvgpr_read_b32 v105, a220
    v_mfma_f32_32x32x16_bf16 v[160:175], a[40:43], a[116:119], v[160:175]
    v_lshlrev_b32 v104, 16, v105
    v_and_b32 v105, s49, v105
    v_accvgpr_read_b32 v107, a221
    v_lshlrev_b32 v106, 16, v107
    v_and_b32 v107, s49, v107
    v_mfma_f32_32x32x16_bf16 v[176:191], a[52:55], a[120:123], v[176:191]
    buffer_load_dwordx4 a[196:199], v12, s[8:11], s30 offen offset:1024 sc1
    v_accvgpr_read_b32 v109, a222
    v_lshlrev_b32 v108, 16, v109
    v_mfma_f32_32x32x16_bf16 v[160:175], a[48:51], a[120:123], v[160:175]
    s_waitcnt lgkmcnt(0)
    s_barrier
    ds_read_b128 v[128:131], v35 offset:4096
    ds_read_b128 v[132:135], v35 offset:5120
    ds_read_b128 v[136:139], v35 offset:6144
    s_waitcnt vmcnt(21)
    v_mfma_f32_32x32x16_bf16 v[176:191], a[60:63], a[124:127], v[176:191]
    buffer_load_dwordx4 a[200:203], v13, s[8:11], s30 offen offset:0 sc1
    ds_read_b128 v[140:143], v35 offset:7168
    ds_read_b128 v[144:147], v35 offset:8192
    v_mfma_f32_32x32x16_bf16 v[160:175], a[56:59], a[124:127], v[160:175]
    ds_read_b128 v[148:151], v35 offset:9216
    ds_read_b128 v[152:155], v35 offset:10240
    ds_read_b128 v[156:159], v35 offset:11264
    v_and_b32 v109, s49, v109
    v_accvgpr_read_b32 v111, a223
    s_waitcnt vmcnt(21)
    v_mfma_f32_32x32x16_bf16 v[176:191], a[68:71], a[128:131], v[176:191]
    buffer_load_dwordx4 a[204:207], v13, s[8:11], s30 offen offset:1024 sc1
    v_lshlrev_b32 v110, 16, v111
    v_and_b32 v111, s49, v111
    v_mfma_f32_32x32x16_bf16 v[160:175], a[64:67], a[128:131], v[160:175]
    s_waitcnt lgkmcnt(0)
    v_add_f32 v128, v128, v144
    v_add_f32 v129, v129, v145
    v_add_f32 v130, v130, v146
    v_add_f32 v131, v131, v147
    s_waitcnt vmcnt(21)
    v_mfma_f32_32x32x16_bf16 v[176:191], a[76:79], a[132:135], v[176:191]
    buffer_load_dwordx4 a[208:211], v14, s[8:11], s31 offen offset:0 sc1
    v_add_f32 v132, v132, v148
    v_add_f32 v133, v133, v149
    v_mfma_f32_32x32x16_bf16 v[160:175], a[72:75], a[132:135], v[160:175]
    v_add_f32 v134, v134, v150
    v_add_f32 v135, v135, v151
    v_add_f32 v136, v136, v152
    v_add_f32 v137, v137, v153
    v_add_f32 v138, v138, v154
    s_waitcnt vmcnt(21)
    v_mfma_f32_32x32x16_bf16 v[176:191], a[84:87], a[136:139], v[176:191]
    buffer_load_dwordx4 a[212:215], v14, s[8:11], s31 offen offset:1024 sc1
    v_add_f32 v139, v139, v155
    v_add_f32 v140, v140, v156
    v_mfma_f32_32x32x16_bf16 v[160:175], a[80:83], a[136:139], v[160:175]
    v_add_f32 v141, v141, v157
    v_add_f32 v142, v142, v158
    v_add_f32 v143, v143, v159
    v_mul_f32 v17, v45, v45
    v_mul_f32 v44, v44, v45
    s_waitcnt vmcnt(21)
    v_mfma_f32_32x32x16_bf16 v[176:191], a[92:95], a[140:143], v[176:191]
    buffer_load_dwordx4 a[224:227], v28, s[8:11], s31 offen offset:0 sc1
    v_fma_f32 v60, v96, v45, -v44
    v_fma_f32 v61, v97, v45, -v44
    v_mfma_f32_32x32x16_bf16 v[160:175], a[88:91], a[140:143], v[160:175]
    v_fma_f32 v62, v98, v45, -v44
    v_fma_f32 v63, v99, v45, -v44
    v_fma_f32 v64, v100, v45, -v44
    v_fma_f32 v65, v101, v45, -v44
    v_fma_f32 v66, v102, v45, -v44
    s_waitcnt vmcnt(21)
    v_mfma_f32_32x32x16_bf16 v[176:191], a[100:103], a[144:147], v[176:191]
    buffer_load_dwordx4 a[228:231], v28, s[8:11], s31 offen offset:1024 sc1
    v_fma_f32 v67, v103, v45, -v44
    v_fma_f32 v68, v104, v45, -v44
    v_mfma_f32_32x32x16_bf16 v[160:175], a[96:99], a[144:147], v[160:175]
    v_fma_f32 v69, v105, v45, -v44
    v_fma_f32 v70, v106, v45, -v44
    v_fma_f32 v71, v107, v45, -v44
    v_fma_f32 v72, v108, v45, -v44
    v_fma_f32 v73, v109, v45, -v44
    s_waitcnt vmcnt(21)
    v_mfma_f32_32x32x16_bf16 v[176:191], a[108:111], a[148:151], v[176:191]
    buffer_load_dwordx4 a[232:235], v29, s[8:11], s31 offen offset:0 sc1
    v_fma_f32 v74, v110, v45, -v44
    v_fma_f32 v75, v111, v45, -v44
    v_mfma_f32_32x32x16_bf16 v[160:175], a[104:107], a[148:151], v[160:175]
    s_waitcnt vmcnt(21)
    v_mfma_f32_32x32x16_bf16 v[208:223], a[4:7], a[152:155], 0
    buffer_load_dwordx4 a[236:239], v29, s[8:11], s31 offen offset:1024 sc1
    v_mfma_f32_32x32x16_bf16 v[192:207], a[0:3], a[152:155], 0
    s_nop 3
    ds_write_b128 v32, v[176:179] offset:0
    ds_write_b128 v32, v[180:183] offset:1024
    ds_write_b128 v32, v[184:187] offset:2048
    s_waitcnt vmcnt(21)
    v_mfma_f32_32x32x16_bf16 v[208:223], a[12:15], a[156:159], v[208:223]
    buffer_load_dwordx4 a[240:243], v30, s[8:11], s31 offen offset:0 sc1
    ds_write_b128 v32, v[188:191] offset:3072
    v_mfma_f32_32x32x16_bf16 v[192:207], a[8:11], a[156:159], v[192:207]
    v_add_f32 v160, v160, v128
    v_add_f32 v161, v161, v129
    v_add_f32 v162, v162, v130
    v_add_f32 v163, v163, v131
    v_add_f32 v164, v164, v132
    s_waitcnt vmcnt(21)
    v_mfma_f32_32x32x16_bf16 v[208:223], a[20:23], a[160:163], v[208:223]
    buffer_load_dwordx4 a[244:247], v30, s[8:11], s31 offen offset:1024 sc1
    v_add_f32 v165, v165, v133
    v_add_f32 v166, v166, v134
    v_mfma_f32_32x32x16_bf16 v[192:207], a[16:19], a[160:163], v[192:207]
    v_add_f32 v167, v167, v135
    v_add_f32 v168, v168, v136
    v_add_f32 v169, v169, v137
    v_add_f32 v170, v170, v138
    v_add_f32 v171, v171, v139
    s_waitcnt vmcnt(21)
    v_mfma_f32_32x32x16_bf16 v[208:223], a[28:31], a[164:167], v[208:223]
    buffer_load_dwordx4 a[248:251], v31, s[8:11], s31 offen offset:0 sc1
    v_add_f32 v172, v172, v140
    v_add_f32 v173, v173, v141
    v_mfma_f32_32x32x16_bf16 v[192:207], a[24:27], a[164:167], v[192:207]
    v_add_f32 v174, v174, v142
    v_add_f32 v175, v175, v143
    s_waitcnt lgkmcnt(0)
    s_barrier
    ds_read_b128 v[176:179], v35 offset:0
    s_waitcnt vmcnt(18)
    v_mfma_f32_32x32x16_bf16 v[208:223], a[36:39], a[168:171], v[208:223]
    buffer_load_dwordx4 a[252:255], v31, s[8:11], s31 offen offset:1024 sc1
    ds_read_b128 v[180:183], v35 offset:1024
    ds_read_b128 v[184:187], v35 offset:2048
    v_mfma_f32_32x32x16_bf16 v[192:207], a[32:35], a[168:171], v[192:207]
    ds_read_b128 v[188:191], v35 offset:3072
    v_mov_b32 v131, s48
    v_mov_b32 v135, s48
    v_mov_b32 v138, s48
    v_mov_b32 v139, s48
    s_waitcnt vmcnt(18)
    v_mfma_f32_32x32x16_bf16 v[208:223], a[44:47], a[172:175], v[208:223]
    buffer_load_dwordx4 a[112:115], v12, s[8:11], s31 offen offset:0 sc1
    buffer_load_dwordx4 v[112:115], v18, s[20:23], s41 offen offset:0 sc1
    buffer_load_dwordx4 v[116:119], v18, s[20:23], s41 offen offset:128 sc1
    buffer_load_dwordx4 v[120:123], v18, s[20:23], s41 offen offset:256 sc1
    v_mfma_f32_32x32x16_bf16 v[192:207], a[40:43], a[172:175], v[192:207]
    s_waitcnt vmcnt(21)
    v_mfma_f32_32x32x16_bf16 v[208:223], a[52:55], a[176:179], v[208:223]
    buffer_load_dwordx4 a[116:119], v12, s[8:11], s31 offen offset:1024 sc1
    s_waitcnt lgkmcnt(0)
    v_add_f32 v160, v160, v176
    v_mfma_f32_32x32x16_bf16 v[192:207], a[48:51], a[176:179], v[192:207]
    v_add_f32 v161, v161, v177
    v_cvt_pk_bf16_f32 v128, v160, v161
    v_add_f32 v162, v162, v178
    v_add_f32 v163, v163, v179
    v_cvt_pk_bf16_f32 v129, v162, v163
    s_waitcnt vmcnt(21)
    v_mfma_f32_32x32x16_bf16 v[208:223], a[60:63], a[180:183], v[208:223]
    buffer_load_dwordx4 a[120:123], v13, s[8:11], s31 offen offset:0 sc1
    v_add_f32 v164, v164, v180
    v_add_f32 v165, v165, v181
    v_mfma_f32_32x32x16_bf16 v[192:207], a[56:59], a[180:183], v[192:207]
    v_cvt_pk_bf16_f32 v130, v164, v165
    v_add_f32 v166, v166, v182
    v_add_f32 v167, v167, v183
    v_cvt_pk_bf16_f32 v132, v166, v167
    v_add_f32 v168, v168, v184
    s_waitcnt vmcnt(21)
    v_mfma_f32_32x32x16_bf16 v[208:223], a[68:71], a[184:187], v[208:223]
    buffer_load_dwordx4 a[124:127], v13, s[8:11], s31 offen offset:1024 sc1
    v_add_f32 v169, v169, v185
    v_cvt_pk_bf16_f32 v133, v168, v169
    v_mfma_f32_32x32x16_bf16 v[192:207], a[64:67], a[184:187], v[192:207]
    v_add_f32 v170, v170, v186
    v_add_f32 v171, v171, v187
    v_cvt_pk_bf16_f32 v134, v170, v171
    v_add_f32 v172, v172, v188
    v_add_f32 v173, v173, v189
    s_waitcnt vmcnt(21)
    v_mfma_f32_32x32x16_bf16 v[208:223], a[76:79], a[188:191], v[208:223]
    v_cvt_pk_bf16_f32 v136, v172, v173
    v_add_f32 v174, v174, v190
    v_add_f32 v175, v175, v191
    v_cvt_pk_bf16_f32 v137, v174, v175
    buffer_store_dwordx4 v[128:131], v4, s[20:23], s42 offen offset:0 sc1
    buffer_store_dwordx4 v[132:135], v4, s[20:23], s42 offen offset:1024 sc1
    buffer_store_dwordx4 v[136:139], v4, s[20:23], s42 offen offset:2048 sc1
    s_xor_b32 s42, s42, 0x4000
    v_mfma_f32_32x32x16_bf16 v[192:207], a[72:75], a[188:191], v[192:207]
    v_subrev_u32 v32, 114688, v32
    v_subrev_u32 v33, 114688, v33
    v_subrev_u32 v34, 114688, v34
    v_subrev_u32 v35, 114688, v35
    s_waitcnt vmcnt(23)
    v_mfma_f32_32x32x16_bf16 v[208:223], a[84:87], a[192:195], v[208:223]
    v_mfma_f32_32x32x16_bf16 v[192:207], a[80:83], a[192:195], v[192:207]
    s_waitcnt vmcnt(22)
    v_mfma_f32_32x32x16_bf16 v[208:223], a[92:95], a[196:199], v[208:223]
    v_mfma_f32_32x32x16_bf16 v[192:207], a[88:91], a[196:199], v[192:207]
    s_waitcnt vmcnt(21)
    v_mfma_f32_32x32x16_bf16 v[208:223], a[100:103], a[200:203], v[208:223]
    v_mfma_f32_32x32x16_bf16 v[192:207], a[96:99], a[200:203], v[192:207]
    s_waitcnt vmcnt(20)
    v_mfma_f32_32x32x16_bf16 v[208:223], a[108:111], a[204:207], v[208:223]
    v_mfma_f32_32x32x16_bf16 v[192:207], a[104:107], a[204:207], v[192:207]
    s_waitcnt vmcnt(19)
    v_mfma_f32_32x32x16_bf16 v[240:255], a[4:7], a[208:211], 0
    v_mfma_f32_32x32x16_bf16 v[224:239], a[0:3], a[208:211], 0
    s_nop 8
    ds_write_b128 v33, v[192:195] offset:0
    s_waitcnt vmcnt(18)
    v_mfma_f32_32x32x16_bf16 v[240:255], a[12:15], a[212:215], v[240:255]
    ds_write_b128 v33, v[196:199] offset:1024
    v_mfma_f32_32x32x16_bf16 v[224:239], a[8:11], a[212:215], v[224:239]
    ds_write_b128 v33, v[200:203] offset:2048
    s_waitcnt vmcnt(17)
    v_mfma_f32_32x32x16_bf16 v[240:255], a[20:23], a[224:227], v[240:255]
    ds_write_b128 v33, v[204:207] offset:3072
    v_mfma_f32_32x32x16_bf16 v[224:239], a[16:19], a[224:227], v[224:239]
    ds_write_b128 v34, v[208:211] offset:0
    s_waitcnt vmcnt(16)
    v_mfma_f32_32x32x16_bf16 v[240:255], a[28:31], a[228:231], v[240:255]
    ds_write_b128 v34, v[212:215] offset:1024
    v_mfma_f32_32x32x16_bf16 v[224:239], a[24:27], a[228:231], v[224:239]
    ds_write_b128 v34, v[216:219] offset:2048
    s_waitcnt vmcnt(15)
    v_mfma_f32_32x32x16_bf16 v[240:255], a[36:39], a[232:235], v[240:255]
    ds_write_b128 v34, v[220:223] offset:3072
    v_mfma_f32_32x32x16_bf16 v[224:239], a[32:35], a[232:235], v[224:239]
    s_waitcnt vmcnt(6)
    s_mov_b32 s63, 0x40000
L_il_y_88:
    v_xor_b32 v124, s48, v115
    v_bitop3_b32 v124, v119, s48, v124 bitop3:0xbe
    v_bitop3_b32 v124, v123, s48, v124 bitop3:0xbe
    v_cmp_ne_u32 vcc, 0, v124
    s_cbranch_vccz L_ilok_y_89
    buffer_load_dwordx4 v[112:115], v18, s[20:23], s41 offen offset:0 sc1
    buffer_load_dwordx4 v[116:119], v18, s[20:23], s41 offen offset:128 sc1
    buffer_load_dwordx4 v[120:123], v18, s[20:23], s41 offen offset:256 sc1
    s_sub_u32 s63, s63, 1
    s_waitcnt vmcnt(0)
    s_cbranch_scc0 L_il_y_88
L_ilok_y_89:
    v_mfma_f32_32x32x16_bf16 v[240:255], a[44:47], a[236:239], v[240:255]
    v_mov_b32 v115, v120
    v_mov_b32 v119, v121
    ds_write_b128 v19, v[112:115]
    ds_write_b128 v19, v[116:119] offset:128
    v_mfma_f32_32x32x16_bf16 v[224:239], a[40:43], a[236:239], v[224:239]
    v_mfma_f32_32x32x16_bf16 v[240:255], a[52:55], a[240:243], v[240:255]
    v_mfma_f32_32x32x16_bf16 v[224:239], a[48:51], a[240:243], v[224:239]
    v_mfma_f32_32x32x16_bf16 v[240:255], a[60:63], a[244:247], v[240:255]
    buffer_load_dwordx4 v[144:147], v4, s[20:23], s42 offen offset:0 sc1
    buffer_load_dwordx4 v[148:151], v4, s[20:23], s42 offen offset:1024 sc1
    buffer_load_dwordx4 v[152:155], v4, s[20:23], s42 offen offset:2048 sc1
    v_mfma_f32_32x32x16_bf16 v[224:239], a[56:59], a[244:247], v[224:239]
    s_waitcnt lgkmcnt(0)
    s_barrier
    ds_read_b128 v[192:195], v35 offset:4096
    ds_read_b128 v[196:199], v35 offset:5120
    ds_read_b128 v[200:203], v35 offset:6144
    v_mfma_f32_32x32x16_bf16 v[240:255], a[68:71], a[248:251], v[240:255]
    ds_read_b128 v[204:207], v35 offset:7168
    ds_read_b128 v[208:211], v35 offset:8192
    ds_read_b128 v[212:215], v35 offset:9216
    ds_read_b128 v[216:219], v35 offset:10240
    ds_read_b128 v[220:223], v35 offset:11264
    v_mfma_f32_32x32x16_bf16 v[224:239], a[64:67], a[248:251], v[224:239]
    ds_read_b64_tr_b16 v[76:77], v20 offset:0
    ds_read_b64_tr_b16 v[78:79], v20 offset:1024
    ds_read_b64_tr_b16 v[80:81], v20 offset:2048
    ds_read_b64_tr_b16 v[82:83], v20 offset:3072
    v_mfma_f32_32x32x16_bf16 v[240:255], a[76:79], a[252:255], v[240:255]
    v_mfma_f32_32x32x16_bf16 v[224:239], a[72:75], a[252:255], v[224:239]
    s_waitcnt lgkmcnt(4)
    v_add_f32 v192, v192, v208
    v_add_f32 v193, v193, v209
    v_add_f32 v194, v194, v210
    v_add_f32 v195, v195, v211
    v_mfma_f32_32x32x16_bf16 v[240:255], a[84:87], a[112:115], v[240:255]
    v_add_f32 v196, v196, v212
    v_add_f32 v197, v197, v213
    v_add_f32 v198, v198, v214
    v_add_f32 v199, v199, v215
    v_add_f32 v200, v200, v216
    v_mfma_f32_32x32x16_bf16 v[224:239], a[80:83], a[112:115], v[224:239]
    v_add_f32 v201, v201, v217
    v_add_f32 v202, v202, v218
    v_add_f32 v203, v203, v219
    v_add_f32 v204, v204, v220
    v_add_f32 v205, v205, v221
    s_waitcnt vmcnt(8)
    v_mfma_f32_32x32x16_bf16 v[240:255], a[92:95], a[116:119], v[240:255]
    v_add_f32 v206, v206, v222
    v_add_f32 v207, v207, v223
    s_waitcnt lgkmcnt(0)
    v_lshlrev_b32 v84, 16, v76
    v_and_b32 v85, s49, v76
    v_mfma_f32_32x32x16_bf16 v[224:239], a[88:91], a[116:119], v[224:239]
    v_fmac_f32 v96, v60, v84
    v_fmac_f32 v97, v61, v85
    v_lshlrev_b32 v86, 16, v77
    v_and_b32 v87, s49, v77
    v_fmac_f32 v98, v62, v86
    s_waitcnt vmcnt(7)
    v_mfma_f32_32x32x16_bf16 v[240:255], a[100:103], a[120:123], v[240:255]
    v_fmac_f32 v99, v63, v87
    v_lshlrev_b32 v84, 16, v78
    v_and_b32 v85, s49, v78
    v_fmac_f32 v100, v64, v84
    v_fmac_f32 v101, v65, v85
    v_mfma_f32_32x32x16_bf16 v[224:239], a[96:99], a[120:123], v[224:239]
    v_lshlrev_b32 v86, 16, v79
    v_and_b32 v87, s49, v79
    v_fmac_f32 v102, v66, v86
    v_fmac_f32 v103, v67, v87
    v_lshlrev_b32 v84, 16, v80
    s_waitcnt vmcnt(6)
    v_mfma_f32_32x32x16_bf16 v[240:255], a[108:111], a[124:127], v[240:255]
    v_and_b32 v85, s49, v80
    v_fmac_f32 v104, v68, v84
    v_fmac_f32 v105, v69, v85
    v_lshlrev_b32 v86, 16, v81
    v_and_b32 v87, s49, v81
    v_mfma_f32_32x32x16_bf16 v[224:239], a[104:107], a[124:127], v[224:239]
    v_fmac_f32 v106, v70, v86
    v_fmac_f32 v107, v71, v87
    v_lshlrev_b32 v84, 16, v82
    v_and_b32 v85, s49, v82
    v_fmac_f32 v108, v72, v84
    v_fmac_f32 v109, v73, v85
    v_lshlrev_b32 v86, 16, v83
    v_and_b32 v87, s49, v83
    v_fmac_f32 v110, v74, v86
    v_fmac_f32 v111, v75, v87
    s_nop 5
    ds_write_b128 v32, v[240:243] offset:0
    ds_write_b128 v32, v[244:247] offset:1024
    ds_write_b128 v32, v[248:251] offset:2048
    ds_write_b128 v32, v[252:255] offset:3072
    v_pk_add_f32 v[224:225], v[224:225], v[192:193]
    v_pk_add_f32 v[226:227], v[226:227], v[194:195]
    v_pk_add_f32 v[228:229], v[228:229], v[196:197]
    v_pk_add_f32 v[230:231], v[230:231], v[198:199]
    v_pk_add_f32 v[232:233], v[232:233], v[200:201]
    v_pk_add_f32 v[234:235], v[234:235], v[202:203]
    v_pk_add_f32 v[236:237], v[236:237], v[204:205]
    v_pk_add_f32 v[238:239], v[238:239], v[206:207]
    s_waitcnt lgkmcnt(0)
    s_barrier
    ds_read_b128 v[240:243], v35 offset:0
    ds_read_b128 v[244:247], v35 offset:1024
    ds_read_b128 v[248:251], v35 offset:2048
    ds_read_b128 v[252:255], v35 offset:3072
    s_waitcnt vmcnt(0)
    s_mov_b32 s63, 0x40000
L_il_xr_90:
    v_xor_b32 v156, s48, v147
    v_bitop3_b32 v156, v151, s48, v156 bitop3:0xbe
    v_bitop3_b32 v156, v155, s48, v156 bitop3:0xbe
    v_cmp_ne_u32 vcc, 0, v156
    s_cbranch_vccz L_ilok_xr_91
    buffer_load_dwordx4 v[144:147], v4, s[20:23], s42 offen offset:0 sc1
    buffer_load_dwordx4 v[148:151], v4, s[20:23], s42 offen offset:1024 sc1
    buffer_load_dwordx4 v[152:155], v4, s[20:23], s42 offen offset:2048 sc1
    s_sub_u32 s63, s63, 1
    s_waitcnt vmcnt(0)
    s_cbranch_scc0 L_il_xr_90
L_ilok_xr_91:
    v_lshlrev_b32 v160, 16, v144
    v_and_b32 v161, s49, v144
    v_lshlrev_b32 v162, 16, v145
    v_and_b32 v163, s49, v145
    v_lshlrev_b32 v164, 16, v146
    v_and_b32 v165, s49, v146
    v_lshlrev_b32 v166, 16, v148
    v_and_b32 v167, s49, v148
    v_lshlrev_b32 v168, 16, v149
    v_and_b32 v169, s49, v149
    v_lshlrev_b32 v170, 16, v150
    v_and_b32 v171, s49, v150
    v_lshlrev_b32 v172, 16, v152
    v_and_b32 v173, s49, v152
    v_lshlrev_b32 v174, 16, v153
    v_and_b32 v175, s49, v153
    v_pk_add_f32 v[224:225], v[224:225], v[160:161]
    v_pk_add_f32 v[226:227], v[226:227], v[162:163]
    v_pk_add_f32 v[228:229], v[228:229], v[164:165]
    v_pk_add_f32 v[230:231], v[230:231], v[166:167]
    v_pk_add_f32 v[232:233], v[232:233], v[168:169]
    v_pk_add_f32 v[234:235], v[234:235], v[170:171]
    v_pk_add_f32 v[236:237], v[236:237], v[172:173]
    v_pk_add_f32 v[238:239], v[238:239], v[174:175]
    s_waitcnt lgkmcnt(0)
    v_pk_add_f32 v[224:225], v[224:225], v[240:241]
    v_pk_add_f32 v[226:227], v[226:227], v[242:243]
    v_pk_add_f32 v[228:229], v[228:229], v[244:245]
    v_pk_add_f32 v[230:231], v[230:231], v[246:247]
    v_pk_add_f32 v[232:233], v[232:233], v[248:249]
    v_pk_add_f32 v[234:235], v[234:235], v[250:251]
    v_pk_add_f32 v[236:237], v[236:237], v[252:253]
    v_pk_add_f32 v[238:239], v[238:239], v[254:255]
    v_mov_b32 v160, v17
    v_mov_b32 v161, v17
    v_pk_fma_f32 v[96:97], v[224:225], v[160:161], v[96:97]
    v_pk_fma_f32 v[98:99], v[226:227], v[160:161], v[98:99]
    v_pk_fma_f32 v[100:101], v[228:229], v[160:161], v[100:101]
    v_pk_fma_f32 v[102:103], v[230:231], v[160:161], v[102:103]
    v_pk_fma_f32 v[104:105], v[232:233], v[160:161], v[104:105]
    v_pk_fma_f32 v[106:107], v[234:235], v[160:161], v[106:107]
    v_pk_fma_f32 v[108:109], v[236:237], v[160:161], v[108:109]
    v_pk_fma_f32 v[110:111], v[238:239], v[160:161], v[110:111]
    v_cvt_pk_bf16_f32 v112, v96, v97
    v_cvt_pk_bf16_f32 v113, v98, v99
    v_cvt_pk_bf16_f32 v114, v100, v101
    v_cvt_pk_bf16_f32 v115, v102, v103
    v_cvt_pk_bf16_f32 v116, v104, v105
    v_cvt_pk_bf16_f32 v117, v106, v107
    v_cvt_pk_bf16_f32 v118, v108, v109
    v_cvt_pk_bf16_f32 v119, v110, v111
    s_nop 1
    v_permlane32_swap_b32 v112, v114
    v_permlane32_swap_b32 v113, v115
    v_permlane32_swap_b32 v116, v118
    v_permlane32_swap_b32 v117, v119
    s_add_u32 s50, s43, 16384
    s_nop 0
    v_permlane16_swap_b32 v112, v116
    v_permlane16_swap_b32 v113, v117
    v_permlane16_swap_b32 v114, v118
    v_permlane16_swap_b32 v115, v119
    buffer_store_dwordx4 v[112:115], v16, s[36:39], s43 offen sc1
    buffer_store_dwordx4 v[116:119], v16, s[36:39], s50 offen sc1
    s_endpgm
L_slow_corr_17:
    s_mov_b32 s63, 0
L_lp_corr_19:
    buffer_load_dwordx3 v[60:62], v13, s[20:23], s66 offen offset:0 sc1
    buffer_load_dwordx3 v[64:66], v13, s[20:23], s66 offen offset:512 sc1
    buffer_load_dwordx3 v[68:70], v13, s[20:23], s75 offen offset:0 sc1
    buffer_load_dwordx3 v[72:74], v13, s[20:23], s75 offen offset:512 sc1
    buffer_load_dwordx3 v[76:78], v13, s[20:23], s67 offen offset:0 sc1
    buffer_load_dwordx3 v[80:82], v13, s[20:23], s67 offen offset:512 sc1
    buffer_load_dwordx4 v[84:87], v13, s[20:23], s65 offen sc1
    s_waitcnt vmcnt(0)
    v_cmp_ne_u32 vcc, s48, v62
    v_cmp_ne_u32 s[52:53], s48, v66
    s_or_b64 vcc, vcc, s[52:53]
    v_cmp_ne_u32 s[52:53], s48, v70
    s_or_b64 vcc, vcc, s[52:53]
    v_cmp_ne_u32 s[52:53], s48, v74
    s_or_b64 vcc, vcc, s[52:53]
    v_cmp_ne_u32 s[52:53], s48, v78
    s_or_b64 vcc, vcc, s[52:53]
    v_cmp_ne_u32 s[52:53], s48, v82
    s_or_b64 vcc, vcc, s[52:53]
    v_cmp_ne_u32 s[52:53], s48, v85
    s_or_b64 vcc, vcc, s[52:53]
    v_cmp_ne_u32 s[52:53], s48, v87
    s_or_b64 vcc, vcc, s[52:53]
    s_cbranch_vccz L_ok_corr_20
    s_sleep 3
    s_add_u32 s63, s63, 1
    s_cmp_lt_u32 s63, 0x10000
    s_cbranch_scc1 L_lp_corr_19
L_ok_corr_20:
    v_mov_b32 v44, v84
    v_mov_b32 v45, v86
    s_nop 1
    s_branch L_back_corr_18
L_slow_u_21:
    s_waitcnt lgkmcnt(0)
    s_mov_b32 s63, 0
L_lp_u_23:
    buffer_load_dwordx4 v[48:51], v7, s[20:23], s71 offen offset:0 sc1
    buffer_load_dwordx4 v[52:55], v7, s[20:23], s71 offen offset:128 sc1
    buffer_load_dwordx4 v[56:59], v7, s[20:23], s71 offen offset:256 sc1
    s_waitcnt vmcnt(0)
    v_cmp_ne_u32 vcc, s48, v51
    v_cmp_ne_u32 s[52:53], s48, v55
    s_or_b64 vcc, vcc, s[52:53]
    v_cmp_ne_u32 s[52:53], s48, v59
    s_or_b64 vcc, vcc, s[52:53]
    s_cbranch_vccz L_ok_u_24
    s_sleep 3
    s_add_u32 s63, s63, 1
    s_cmp_lt_u32 s63, 0x10000
    s_cbranch_scc1 L_lp_u_23
L_ok_u_24:
    v_mov_b32 v51, v56
    v_mov_b32 v55, v57
    ds_write_b128 v15, v[48:51] offset:4576
    v_alignbit_b32 v92, v49, v48, 16
    v_alignbit_b32 v93, v50, v49, 16
    v_alignbit_b32 v94, v51, v50, 16
    v_alignbit_b32 v95, v58, v51, 16
    ds_write_b128 v15, v[92:95] offset:0
    ds_write_b128 v15, v[52:55] offset:13728
    v_alignbit_b32 v96, v53, v52, 16
    v_alignbit_b32 v97, v54, v53, 16
    v_alignbit_b32 v98, v55, v54, 16
    v_perm_b32 v99, v58, v55, s70
    ds_write_b128 v15, v[96:99] offset:9152
    s_branch L_back_u_22
L_slow_h2_26:
    s_mov_b64 exec, 0x7f
    buffer_load_dword v43, v5, s[20:23], s27 offen sc1
    s_mov_b64 exec, -1
L_h2done_29:
    s_branch L_back_h2_27
L_slow_h2_30:
    s_waitcnt vmcnt(6)
    v_cmp_ne_u32 vcc, s48, v43
    s_cbranch_vccnz L_h2skip_32
    s_mov_b32 s75, 0
    s_mov_b32 s10, 33554432
    buffer_load_dwordx4 v[192:195], v28, s[8:11], s28 offen offset:0 sc1
    buffer_load_dwordx4 v[196:199], v28, s[8:11], s28 offen offset:1024 sc1
    buffer_load_dwordx4 v[200:203], v29, s[8:11], s28 offen offset:0 sc1
    buffer_load_dwordx4 v[204:207], v29, s[8:11], s28 offen offset:1024 sc1
    buffer_load_dwordx4 v[208:211], v30, s[8:11], s28 offen offset:0 sc1
    buffer_load_dwordx4 v[212:215], v30, s[8:11], s28 offen offset:1024 sc1
    s_branch L_h2done_33
L_h2skip_32:
    s_mov_b64 exec, 0x7f
    buffer_load_dword v43, v5, s[20:23], s27 offen sc1
    s_mov_b64 exec, -1
L_h2done_33:
    s_branch L_back_h2_31
L_slow_h2_34:
    s_waitcnt vmcnt(6)
    v_cmp_ne_u32 vcc, s48, v43
    s_cbranch_vccnz L_h2skip_36
    s_mov_b32 s75, 0
    s_mov_b32 s10, 33554432
    buffer_load_dwordx4 v[192:195], v28, s[8:11], s28 offen offset:0 sc1
    buffer_load_dwordx4 v[196:199], v28, s[8:11], s28 offen offset:1024 sc1
    buffer_load_dwordx4 v[200:203], v29, s[8:11], s28 offen offset:0 sc1
    buffer_load_dwordx4 v[204:207], v29, s[8:11], s28 offen offset:1024 sc1
    buffer_load_dwordx4 v[208:211], v30, s[8:11], s28 offen offset:0 sc1
    buffer_load_dwordx4 v[212:215], v30, s[8:11], s28 offen offset:1024 sc1
    buffer_load_dwordx4 v[216:219], v31, s[8:11], s28 offen offset:0 sc1
    buffer_load_dwordx4 v[220:223], v31, s[8:11], s28 offen offset:1024 sc1
    buffer_load_dwordx4 v[224:227], v12, s[8:11], s28 offen offset:0 sc1
    buffer_load_dwordx4 v[228:231], v12, s[8:11], s28 offen offset:1024 sc1
    buffer_load_dwordx4 v[232:235], v13, s[8:11], s28 offen offset:0 sc1
    buffer_load_dwordx4 v[236:239], v13, s[8:11], s28 offen offset:1024 sc1
    s_branch L_h2done_37
L_h2skip_36:
    s_mov_b64 exec, 0x7f
    buffer_load_dword v43, v5, s[20:23], s27 offen sc1
    s_mov_b64 exec, -1
L_h2done_37:
    s_branch L_back_h2_35
L_slow_h_38:
    s_mov_b32 s63, 0
L_lp_h_40:
    s_mov_b64 exec, 0x7f
    buffer_load_dword v43, v5, s[20:23], s27 offen sc1
    s_mov_b64 exec, -1
    s_waitcnt vmcnt(0)
    v_cmp_ne_u32 vcc, s48, v43
    s_cbranch_vccz L_ok_h_41
    s_sleep 3
    s_add_u32 s63, s63, 1
    s_cmp_lt_u32 s63, 0x10000
    s_cbranch_scc1 L_lp_h_40
L_ok_h_41:
    s_mov_b32 s10, 33554432
    buffer_load_dwordx4 v[192:195], v28, s[8:11], s28 offen offset:0 sc1
    buffer_load_dwordx4 v[196:199], v28, s[8:11], s28 offen offset:1024 sc1
    buffer_load_dwordx4 v[200:203], v29, s[8:11], s28 offen offset:0 sc1
    buffer_load_dwordx4 v[204:207], v29, s[8:11], s28 offen offset:1024 sc1
    buffer_load_dwordx4 v[208:211], v30, s[8:11], s28 offen offset:0 sc1
    buffer_load_dwordx4 v[212:215], v30, s[8:11], s28 offen offset:1024 sc1
    buffer_load_dwordx4 v[216:219], v31, s[8:11], s28 offen offset:0 sc1
    buffer_load_dwordx4 v[220:223], v31, s[8:11], s28 offen offset:1024 sc1
    buffer_load_dwordx4 v[224:227], v12, s[8:11], s28 offen offset:0 sc1
    buffer_load_dwordx4 v[228:231], v12, s[8:11], s28 offen offset:1024 sc1
    buffer_load_dwordx4 v[232:235], v13, s[8:11], s28 offen offset:0 sc1
    buffer_load_dwordx4 v[236:239], v13, s[8:11], s28 offen offset:1024 sc1
    buffer_load_dwordx4 v[240:243], v28, s[8:11], s29 offen offset:0 sc1
    s_branch L_back_h_39
L_slow_hb_42:
    s_mov_b32 s63, 0
L_lp_hb_44:
    s_mov_b64 exec, 0x7f
    buffer_load_dword v8, v5, s[20:23], s66 offen sc1
    s_mov_b64 exec, -1
    s_waitcnt vmcnt(0)
    v_cmp_ne_u32 vcc, s48, v8
    s_cbranch_vccz L_ok_hb_45
    s_sleep 3
    s_add_u32 s63, s63, 1
    s_cmp_lt_u32 s63, 0x10000
    s_cbranch_scc1 L_lp_hb_44
L_ok_hb_45:
    s_branch L_back_hb_43
L_slow_st_50:
    s_mov_b32 s63, 0
L_lp_st_52:
    buffer_load_dwordx4 v[84:87], v8, s[20:23], s66 offen sc1
    s_waitcnt vmcnt(0)
    v_cmp_ne_u32 vcc, s48, v85
    v_cmp_ne_u32 s[52:53], s48, v87
    s_or_b64 vcc, vcc, s[52:53]
    s_cbranch_vccz L_ok_st_53
    s_sleep 3
    s_add_u32 s63, s63, 1
    s_cmp_lt_u32 s63, 0x10000
    s_cbranch_scc1 L_lp_st_52
L_ok_st_53:
    s_branch L_back_st_51
L_slow_u_54:
    s_waitcnt lgkmcnt(0)
    s_mov_b32 s63, 0
L_lp_u_56:
    buffer_load_dwordx4 v[48:51], v7, s[20:23], s71 offen offset:0 sc1
    buffer_load_dwordx4 v[52:55], v7, s[20:23], s71 offen offset:128 sc1
    buffer_load_dwordx4 v[56:59], v7, s[20:23], s71 offen offset:256 sc1
    s_waitcnt vmcnt(0)
    v_cmp_ne_u32 vcc, s48, v51
    v_cmp_ne_u32 s[52:53], s48, v55
    s_or_b64 vcc, vcc, s[52:53]
    v_cmp_ne_u32 s[52:53], s48, v59
    s_or_b64 vcc, vcc, s[52:53]
    s_cbranch_vccz L_ok_u_57
    s_sleep 3
    s_add_u32 s63, s63, 1
    s_cmp_lt_u32 s63, 0x10000
    s_cbranch_scc1 L_lp_u_56
L_ok_u_57:
    v_mov_b32 v51, v56
    v_mov_b32 v55, v57
    ds_write_b128 v15, v[48:51] offset:4576
    v_alignbit_b32 v92, v49, v48, 16
    v_alignbit_b32 v93, v50, v49, 16
    v_alignbit_b32 v94, v51, v50, 16
    v_alignbit_b32 v95, v58, v51, 16
    ds_write_b128 v15, v[92:95] offset:0
    ds_write_b128 v15, v[52:55] offset:13728
    v_alignbit_b32 v96, v53, v52, 16
    v_alignbit_b32 v97, v54, v53, 16
    v_alignbit_b32 v98, v55, v54, 16
    v_perm_b32 v99, v58, v55, s70
    ds_write_b128 v15, v[96:99] offset:9152
    s_branch L_back_u_55
L_slow_h2_59:
    s_mov_b64 exec, 0x7f
    buffer_load_dword v43, v5, s[20:23], s27 offen sc1
    s_mov_b64 exec, -1
L_h2done_62:
    s_branch L_back_h2_60
L_slow_h2_63:
    s_waitcnt vmcnt(6)
    v_cmp_ne_u32 vcc, s48, v43
    s_cbranch_vccnz L_h2skip_65
    s_mov_b32 s75, 0
    s_mov_b32 s10, 33554432
    buffer_load_dwordx4 v[192:195], v14, s[8:11], s28 offen offset:0 sc1
    buffer_load_dwordx4 v[196:199], v14, s[8:11], s28 offen offset:1024 sc1
    buffer_load_dwordx4 v[200:203], v28, s[8:11], s28 offen offset:0 sc1
    buffer_load_dwordx4 v[204:207], v28, s[8:11], s28 offen offset:1024 sc1
    buffer_load_dwordx4 v[208:211], v29, s[8:11], s28 offen offset:0 sc1
    buffer_load_dwordx4 v[212:215], v29, s[8:11], s28 offen offset:1024 sc1
    s_branch L_h2done_66
L_h2skip_65:
    s_mov_b64 exec, 0x7f
    buffer_load_dword v43, v5, s[20:23], s27 offen sc1
    s_mov_b64 exec, -1
L_h2done_66:
    s_branch L_back_h2_64
L_slow_h2_67:
    s_waitcnt vmcnt(6)
    v_cmp_ne_u32 vcc, s48, v43
    s_cbranch_vccnz L_h2skip_69
    s_mov_b32 s75, 0
    s_mov_b32 s10, 33554432
    buffer_load_dwordx4 v[192:195], v14, s[8:11], s28 offen offset:0 sc1
    buffer_load_dwordx4 v[196:199], v14, s[8:11], s28 offen offset:1024 sc1
    buffer_load_dwordx4 v[200:203], v28, s[8:11], s28 offen offset:0 sc1
    buffer_load_dwordx4 v[204:207], v28, s[8:11], s28 offen offset:1024 sc1
    buffer_load_dwordx4 v[208:211], v29, s[8:11], s28 offen offset:0 sc1
    buffer_load_dwordx4 v[212:215], v29, s[8:11], s28 offen offset:1024 sc1
    buffer_load_dwordx4 v[216:219], v30, s[8:11], s28 offen offset:0 sc1
    buffer_load_dwordx4 v[220:223], v30, s[8:11], s28 offen offset:1024 sc1
    buffer_load_dwordx4 v[224:227], v31, s[8:11], s28 offen offset:0 sc1
    buffer_load_dwordx4 v[228:231], v31, s[8:11], s28 offen offset:1024 sc1
    buffer_load_dwordx4 v[232:235], v12, s[8:11], s28 offen offset:0 sc1
    buffer_load_dwordx4 v[236:239], v12, s[8:11], s28 offen offset:1024 sc1
    s_branch L_h2done_70
L_h2skip_69:
    s_mov_b64 exec, 0x7f
    buffer_load_dword v43, v5, s[20:23], s27 offen sc1
    s_mov_b64 exec, -1
L_h2done_70:
    s_branch L_back_h2_68
L_slow_h2_71:
    s_waitcnt vmcnt(6)
    v_cmp_ne_u32 vcc, s48, v43
    s_cbranch_vccnz L_h2skip_73
    s_mov_b32 s75, 0
    s_mov_b32 s10, 33554432
    buffer_load_dwordx4 v[192:195], v14, s[8:11], s28 offen offset:0 sc1
    buffer_load_dwordx4 v[196:199], v14, s[8:11], s28 offen offset:1024 sc1
    buffer_load_dwordx4 v[200:203], v28, s[8:11], s28 offen offset:0 sc1
    buffer_load_dwordx4 v[204:207], v28, s[8:11], s28 offen offset:1024 sc1
    buffer_load_dwordx4 v[208:211], v29, s[8:11], s28 offen offset:0 sc1
    buffer_load_dwordx4 v[212:215], v29, s[8:11], s28 offen offset:1024 sc1
    buffer_load_dwordx4 v[216:219], v30, s[8:11], s28 offen offset:0 sc1
    buffer_load_dwordx4 v[220:223], v30, s[8:11], s28 offen offset:1024 sc1
    buffer_load_dwordx4 v[224:227], v31, s[8:11], s28 offen offset:0 sc1
    buffer_load_dwordx4 v[228:231], v31, s[8:11], s28 offen offset:1024 sc1
    buffer_load_dwordx4 v[232:235], v12, s[8:11], s28 offen offset:0 sc1
    buffer_load_dwordx4 v[236:239], v12, s[8:11], s28 offen offset:1024 sc1
    buffer_load_dwordx4 v[240:243], v13, s[8:11], s28 offen offset:0 sc1
    buffer_load_dwordx4 v[244:247], v13, s[8:11], s28 offen offset:1024 sc1
    buffer_load_dwordx4 v[248:251], v14, s[8:11], s29 offen offset:0 sc1
    buffer_load_dwordx4 v[252:255], v14, s[8:11], s29 offen offset:1024 sc1
    buffer_load_dwordx4 a[248:251], v28, s[8:11], s29 offen offset:0 sc1
    buffer_load_dwordx4 a[252:255], v28, s[8:11], s29 offen offset:1024 sc1
    s_branch L_h2done_74
L_h2skip_73:
    s_mov_b64 exec, 0x7f
    buffer_load_dword v43, v5, s[20:23], s27 offen sc1
    s_mov_b64 exec, -1
L_h2done_74:
    s_branch L_back_h2_72
L_slow_gen_76:
    s_mov_b32 s63, 0
L_lp_gen_78:
    buffer_load_dword v92, v15, s[20:23], s72 offen offset:0 sc1
    buffer_load_dword v93, v15, s[20:23], s72 offen offset:384 sc1
    buffer_load_dword v94, v15, s[20:23], s72 offen offset:768 sc1
    buffer_load_dword v95, v15, s[20:23], s72 offen offset:1152 sc1
    s_waitcnt vmcnt(0)
    v_cmp_ne_u32 vcc, s48, v92
    v_cmp_ne_u32 s[52:53], s48, v93
    s_or_b64 vcc, vcc, s[52:53]
    v_cmp_ne_u32 s[52:53], s48, v94
    s_or_b64 vcc, vcc, s[52:53]
    v_cmp_ne_u32 s[52:53], s48, v95
    s_or_b64 vcc, vcc, s[52:53]
    s_cbranch_vccz L_ok_gen_79
    s_sleep 3
    s_add_u32 s63, s63, 1
    s_cmp_lt_u32 s63, 0x10000
    s_cbranch_scc1 L_lp_gen_78
L_ok_gen_79:
    s_branch L_back_gen_77
L_slow_h_80:
    s_mov_b32 s63, 0
L_lp_h_82:
    s_mov_b64 exec, 0x7f
    buffer_load_dword v43, v5, s[20:23], s27 offen sc1
    s_mov_b64 exec, -1
    s_waitcnt vmcnt(0)
    v_cmp_ne_u32 vcc, s48, v43
    s_cbranch_vccz L_ok_h_83
    s_sleep 3
    s_add_u32 s63, s63, 1
    s_cmp_lt_u32 s63, 0x10000
    s_cbranch_scc1 L_lp_h_82
L_ok_h_83:
    s_mov_b32 s10, 33554432
    buffer_load_dwordx4 v[192:195], v14, s[8:11], s28 offen offset:0 sc1
    buffer_load_dwordx4 v[196:199], v14, s[8:11], s28 offen offset:1024 sc1
    buffer_load_dwordx4 v[200:203], v28, s[8:11], s28 offen offset:0 sc1
    buffer_load_dwordx4 v[204:207], v28, s[8:11], s28 offen offset:1024 sc1
    buffer_load_dwordx4 v[208:211], v29, s[8:11], s28 offen offset:0 sc1
    buffer_load_dwordx4 v[212:215], v29, s[8:11], s28 offen offset:1024 sc1
    buffer_load_dwordx4 v[216:219], v30, s[8:11], s28 offen offset:0 sc1
    buffer_load_dwordx4 v[220:223], v30, s[8:11], s28 offen offset:1024 sc1
    buffer_load_dwordx4 v[224:227], v31, s[8:11], s28 offen offset:0 sc1
    buffer_load_dwordx4 v[228:231], v31, s[8:11], s28 offen offset:1024 sc1
    buffer_load_dwordx4 v[232:235], v12, s[8:11], s28 offen offset:0 sc1
    buffer_load_dwordx4 v[236:239], v12, s[8:11], s28 offen offset:1024 sc1
    buffer_load_dwordx4 v[240:243], v13, s[8:11], s28 offen offset:0 sc1
    buffer_load_dwordx4 v[244:247], v13, s[8:11], s28 offen offset:1024 sc1
    buffer_load_dwordx4 v[248:251], v14, s[8:11], s29 offen offset:0 sc1
    buffer_load_dwordx4 v[252:255], v14, s[8:11], s29 offen offset:1024 sc1
    buffer_load_dwordx4 a[248:251], v28, s[8:11], s29 offen offset:0 sc1
    buffer_load_dwordx4 a[252:255], v28, s[8:11], s29 offen offset:1024 sc1
    buffer_load_dwordx4 a[112:115], v29, s[8:11], s29 offen offset:0 sc1
    s_branch L_back_h_81
L_slow_hb_84:
    s_mov_b32 s63, 0
L_lp_hb_86:
    s_mov_b64 exec, 0x7f
    buffer_load_dword v8, v5, s[20:23], s66 offen sc1
    s_mov_b64 exec, -1
    s_waitcnt vmcnt(0)
    v_cmp_ne_u32 vcc, s48, v8
    s_cbranch_vccz L_ok_hb_87
    s_sleep 3
    s_add_u32 s63, s63, 1
    s_cmp_lt_u32 s63, 0x10000
    s_cbranch_scc1 L_lp_hb_86
L_ok_hb_87:
    s_branch L_back_hb_85
L_end:
s_endpgm
.section .rodata,"a"
.p2align 6
.amdhsa_kernel parallel_sum__ssm_conv_h3__glu_gated_reglu__prompt_kernel
  .amdhsa_next_free_vgpr 512
  .amdhsa_next_free_sgpr 102
  .amdhsa_accum_offset 256
  .amdhsa_group_segment_fixed_size 0
  .amdhsa_kernarg_size 104
  .amdhsa_user_sgpr_count 2
  .amdhsa_user_sgpr_kernarg_segment_ptr 1
  .amdhsa_system_sgpr_workgroup_id_x 1
.end_amdhsa_kernel
```
